```python
import torch

def _softmax(x, axis=-1):
    return torch.softmax(x, dim=axis)
def _gelu(x):
    return torch.nn.functional.gelu(x, approximate="tanh")
def _silu(x):
    return torch.nn.functional.silu(x)
def _sigmoid(x):
    return torch.sigmoid(x)
def _layernorm(x, axis=-1, eps=1e-5):
    m = x.mean(dim=axis, keepdim=True)
    v = x.var(dim=axis, keepdim=True, unbiased=False)
    return (x - m) / torch.sqrt(v + eps)
def _scatter_add(tgt, idx, src, axis=0):
    return tgt.clone().index_add_(axis, idx, src)
def _segment_sum(src, seg, n):
    out = torch.zeros((n,) + src.shape[1:], dtype=src.dtype)
    return out.index_add_(0, seg, src)
def _pad(x, pw):
    flat = tuple(v for pair in reversed(pw) for v in pair)
    return torch.nn.functional.pad(x, flat)

kernel_name = 'interleave_layers__mha_block_cached__glu_gated_reglu__decode'

def setup_inputs():

    _w = (lambda a: (lambda t: t.to(torch.bfloat16) if t.is_floating_point() else t)(torch.as_tensor(a)))
    def _A_setup():
        B, Sq, D = 2, 1, 640
        H, Sk, Dh = 32, 4096, 192
        return {
            "x": _w((lambda *s: torch.randn(*s, dtype=torch.bfloat16) * 0.05)(B, Sq, D)),
            "k_cache": _w((lambda *s: torch.randn(*s, dtype=torch.bfloat16) * 0.8)(B, H, Sk, Dh)),
            "v_cache": _w((lambda *s: torch.randn(*s, dtype=torch.bfloat16) * 0.8)(B, H, Sk, Dh)),
            "wq": _w((lambda *s: torch.randn(*s, dtype=torch.bfloat16) * 0.8)(D, H * Dh) * (D ** -0.5)),
            "wo": _w((lambda *s: torch.randn(*s, dtype=torch.bfloat16) * 0.8)(H * Dh, D) * ((H * Dh) ** -0.5)),
        }
    _A_in = _A_setup()

    def _B_setup():
        B, S, D, F = 2, 1, 640, 1536
        return {
            "x": _w((lambda *s: torch.randn(*s, dtype=torch.bfloat16) * 0.05)(B, S, D)),
            "W_gate": _w((lambda *s: torch.randn(*s, dtype=torch.bfloat16) * 0.2)(D, F) * (2.0 / D) ** 0.5),
            "W_up": _w((lambda *s: torch.randn(*s, dtype=torch.bfloat16) * 0.2)(D, F) * (2.0 / D) ** 0.5),
            "W_down": _w((lambda *s: torch.randn(*s, dtype=torch.bfloat16) * 0.2)(F, D) * (1.0 / F) ** 0.5),
        }
    _B_in = _B_setup()

    return {
        "A_x": _A_in["x"],
        "A_k_cache": _A_in["k_cache"],
        "A_v_cache": _A_in["v_cache"],
        "A_wq": _A_in["wq"],
        "A_wo": _A_in["wo"],
        "B_x": _B_in["x"],
        "B_W_gate": _B_in["W_gate"],
        "B_W_up": _B_in["W_up"],
        "B_W_down": _B_in["W_down"],
    }

def reference(A_x, A_k_cache, A_v_cache, A_wq, A_wo, B_x, B_W_gate, B_W_up, B_W_down):
    def _A_ref(x, k_cache, v_cache, wq, wo):
        B, Sq, D = x.shape
        H, Dh = 32, 192
        q = (lambda x, *d: x.permute(*d))((x @ wq).reshape(B, Sq, H, Dh), 0, 2, 1, 3)
        scores = torch.einsum("bhqd,bhkd->bhqk", q, k_cache) * (Dh ** -0.5)
        p = _softmax(scores, axis=-1)
        o = torch.einsum("bhqk,bhkd->bhqd", p, v_cache)
        return (lambda x, *d: x.permute(*d))(o, 0, 2, 1, 3).reshape(B, Sq, H * Dh) @ wo

    def _B_ref(x, W_gate, W_up, W_down):
        gate = torch.einsum("bsd,df->bsf", x, W_gate)
        up = torch.einsum("bsd,df->bsf", x, W_up)
        gate = gate * (lambda x, dt: x.to(dt))(gate > 0, gate.dtype)
        h = gate * up
        return torch.einsum("bsf,fd->bsd", h, W_down)

    x = A_x
    x = x + _A_ref(_layernorm(x, axis=-1), A_k_cache, A_v_cache, A_wq, A_wo)
    x = x + _B_ref(_layernorm(x, axis=-1), B_W_gate, B_W_up, B_W_down)
    x = x + _A_ref(_layernorm(x, axis=-1), A_k_cache, A_v_cache, A_wq, A_wo)
    x = x + _B_ref(_layernorm(x, axis=-1), B_W_gate, B_W_up, B_W_down)
    return x
```

```asm
; @launch grid=(256,1,1) block=(256,1,1) lds=163840
.amdgcn_target "amdgcn-amd-amdhsa--gfx950"
.text
.globl interleave_layers__mha_block_cached__glu_gated_reglu__decode_kernel
.p2align 8
.type interleave_layers__mha_block_cached__glu_gated_reglu__decode_kernel,@function
interleave_layers__mha_block_cached__glu_gated_reglu__decode_kernel:
    s_cmp_ge_u32 s2, 256
    s_cbranch_scc1 L_end
    s_load_dwordx16 s[64:79], s[0:1], 0
    s_load_dwordx8 s[80:87], s[0:1], 64
    v_lshrrev_b32 v1, 6, v0
    v_and_b32 v0, 63, v0
    v_readfirstlane_b32 s3, v1
    s_and_b32 s54, s2, 7
    s_lshr_b32 s55, s2, 3
    s_lshr_b32 s56, s55, 3
    s_and_b32 s57, s55, 7
    s_lshl_b32 s58, s54, 2
    s_add_u32 s58, s58, s56
    s_lshr_b32 s59, s57, 2
    s_and_b32 s60, s57, 3
    s_lshl_b32 s53, s59, 5
    s_add_u32 s53, s53, s58
    s_lshl_b32 s53, s53, 2
    s_add_u32 s53, s53, s60
    s_lshl_b32 s53, s53, 2
    s_add_u32 s53, s53, s3
    s_mul_i32 s52, s53, 98304
    v_and_b32 v1, 7, v0
    v_mul_u32_u24 v1, 384, v1
    v_bfe_u32 v63, v0, 3, 1
    v_lshl_add_u32 v1, v63, 6, v1
    v_lshrrev_b32 v62, 4, v0
    v_lshl_add_u32 v1, v62, 4, v1
    s_waitcnt lgkmcnt(0)
    s_mov_b32 s4, s66
    s_mov_b32 s5, s67
    s_mov_b32 s6, 100663296
    s_mov_b32 s7, 0x20000
    s_add_u32 s48, s52, 0
    buffer_load_dwordx4 a[0:3], v1, s[4:7], s48 offen offset:0 sc1 nt
    buffer_load_dwordx4 a[4:7], v1, s[4:7], s48 offen offset:128 sc1 nt
    buffer_load_dwordx4 a[8:11], v1, s[4:7], s48 offen offset:256 sc1 nt
    s_add_u32 s48, s52, 3072
    buffer_load_dwordx4 a[12:15], v1, s[4:7], s48 offen offset:0 sc1 nt
    buffer_load_dwordx4 a[16:19], v1, s[4:7], s48 offen offset:128 sc1 nt
    buffer_load_dwordx4 a[20:23], v1, s[4:7], s48 offen offset:256 sc1 nt
    s_add_u32 s48, s52, 6144
    buffer_load_dwordx4 a[24:27], v1, s[4:7], s48 offen offset:0 sc1 nt
    buffer_load_dwordx4 a[28:31], v1, s[4:7], s48 offen offset:128 sc1 nt
    buffer_load_dwordx4 a[32:35], v1, s[4:7], s48 offen offset:256 sc1 nt
    s_add_u32 s48, s52, 9216
    buffer_load_dwordx4 a[36:39], v1, s[4:7], s48 offen offset:0 sc1 nt
    buffer_load_dwordx4 a[40:43], v1, s[4:7], s48 offen offset:128 sc1 nt
    buffer_load_dwordx4 a[44:47], v1, s[4:7], s48 offen offset:256 sc1 nt
    s_add_u32 s48, s52, 12288
    buffer_load_dwordx4 a[48:51], v1, s[4:7], s48 offen offset:0 sc1 nt
    buffer_load_dwordx4 a[52:55], v1, s[4:7], s48 offen offset:128 sc1 nt
    buffer_load_dwordx4 a[56:59], v1, s[4:7], s48 offen offset:256 sc1 nt
    s_add_u32 s48, s52, 15360
    buffer_load_dwordx4 a[60:63], v1, s[4:7], s48 offen offset:0 sc1 nt
    s_mov_b32 s8, s68
    s_mov_b32 s9, s69
    s_mov_b32 s10, 100663296
    s_mov_b32 s11, 0x20000
    s_mov_b32 s12, s86
    s_mov_b32 s13, s87
    s_mov_b32 s14, 524288
    s_mov_b32 s15, 0x20000
    s_mov_b32 s16, s70
    s_mov_b32 s17, s71
    s_mov_b32 s18, 7864320
    s_mov_b32 s19, 0x20000
    s_mov_b32 s20, s72
    s_mov_b32 s21, s73
    s_mov_b32 s22, 7864320
    s_mov_b32 s23, 0x20000
    s_mov_b32 s24, s76
    s_mov_b32 s25, s77
    s_mov_b32 s26, 1966080
    s_mov_b32 s27, 0x20000
    s_mov_b32 s28, s78
    s_mov_b32 s29, s79
    s_mov_b32 s30, 1966080
    s_mov_b32 s31, 0x20000
    s_mov_b32 s32, s80
    s_mov_b32 s33, s81
    s_mov_b32 s34, 1966080
    s_mov_b32 s35, 0x20000
    s_mov_b32 s36, s64
    s_mov_b32 s37, s65
    s_mov_b32 s38, 2560
    s_mov_b32 s39, 0x20000
    s_mov_b32 s40, s82
    s_mov_b32 s41, s83
    s_mov_b32 s42, 2560
    s_mov_b32 s43, 0x20000
    s_mov_b32 s44, s84
    s_mov_b32 s45, s85
    s_mov_b32 s46, 256
    s_mov_b32 s47, 0x20000
    s_cmp_lt_u32 s57, 6
    s_cselect_b32 s72, 1, 0
    s_cselect_b32 s18, 7864320, 0
    s_cmp_lt_u32 s57, 3
    s_cselect_b32 s73, 1, 0
    s_cselect_b32 s74, 0, 1
    s_cselect_b32 s22, 0, 7864320
    s_mul_i32 s63, s56, 5
    s_add_u32 s63, s63, s57
    s_sub_u32 s63, s63, 3
    s_mul_i32 s64, s54, 12
    s_mul_i32 s53, s56, 3
    s_add_u32 s64, s64, s53
    s_add_u32 s64, s64, s57
    s_cmp_eq_u32 s57, 7
    s_cselect_b32 s75, 1, 0
    s_cselect_b32 s53, s56, 4
    s_cmp_eq_u32 s55, 6
    s_cselect_b32 s75, 1, s75
    s_mul_i32 s65, s54, 5
    s_add_u32 s65, s65, s53
    s_lshl_b32 s53, s58, 1
    s_add_u32 s53, s53, s59
    s_lshl_b32 s53, s53, 2
    s_add_u32 s53, s53, s60
    s_lshl_b32 s53, s53, 9
    s_add_u32 s76, s53, 32768
    s_mul_i32 s66, s3, 12288
    s_mul_i32 s67, s3, 27648
    s_add_u32 s67, s67, 53248
    s_mov_b32 s61, 0
    s_mov_b32 s77, 300000
    s_getreg_b32 s86, hwreg(HW_REG_XCC_ID, 0, 4)
    s_mov_b32 s87, 0
    s_cmp_eq_u32 s3, 3
    s_cbranch_scc0 L_noclr_1
    v_mov_b32 v4, -1
    v_mov_b32 v5, -1
    v_mov_b32 v6, -1
    v_mov_b32 v7, -1
    v_lshrrev_b32 v10, 3, v0
    v_and_b32 v2, 7, v0
    v_lshlrev_b32 v2, 4, v2
    v_and_b32 v3, 3, v10
    v_lshl_add_u32 v3, v3, 7, v2
    v_lshrrev_b32 v8, 2, v10
    v_lshl_add_u32 v3, v8, 18, v3
    buffer_store_dwordx4 v[4:7], v3, s[12:15], s76 offen sc1
    s_mul_i32 s53, s58, 6
    s_add_u32 s53, s53, s57
    s_lshl_b32 s53, s53, 7
    s_add_u32 s53, s53, 0
    s_cmp_eq_u32 s72, 1
    s_cselect_b32 s53, s53, 1048576
    s_mul_i32 s69, s54, 20
    s_add_u32 s69, s69, s63
    s_lshl_b32 s69, s69, 7
    s_add_u32 s69, s69, 163840
    s_lshl_b32 s70, s64, 7
    s_add_u32 s70, s70, 188416
    s_cmp_eq_u32 s74, 1
    s_cselect_b32 s69, s69, s70
    s_lshl_b32 s70, s65, 7
    s_add_u32 s70, s70, 204800
    s_cmp_eq_u32 s75, 1
    s_cselect_b32 s70, s70, 1048576
    v_mov_b32 v3, 1048576
    v_mov_b32 v8, s53
    v_cmp_gt_u32 vcc, 2, v10
    s_nop 1
    v_cndmask_b32 v3, v3, v8, vcc
    v_mov_b32 v8, s69
    v_lshrrev_b32 v9, 1, v10
    v_cmp_eq_u32 vcc, 1, v9
    s_nop 1
    v_cndmask_b32 v3, v3, v8, vcc
    v_mov_b32 v8, s70
    v_cmp_eq_u32 vcc, 4, v10
    s_nop 1
    v_cndmask_b32 v3, v3, v8, vcc
    v_and_b32 v9, 1, v10
    v_lshl_add_u32 v3, v9, 18, v3
    v_add_u32 v3, v3, v2
    buffer_store_dwordx4 v[4:7], v3, s[12:15], 0 offen sc1
    s_lshl_b32 s53, s2, 2
    s_add_u32 s53, s53, 212992
    v_mov_b32 v8, s86
    v_mov_b32 v9, 0
    s_mov_b64 exec, 1
    buffer_store_dword v8, v9, s[12:15], s53 offen sc1
    s_mov_b64 exec, -1
L_noclr_1:
    v_mov_b32 v12, 0x3f803f80
    v_mov_b32 v13, 0x3f803f80
    v_mov_b32 v14, 0x3f803f80
    v_mov_b32 v15, 0x3f803f80
    v_mov_b32 v16, 0x3f803f80
    v_mov_b32 v17, 0x3f803f80
    v_mov_b32 v18, 0x3f803f80
    v_mov_b32 v19, 0x3f803f80
    v_mov_b32 v20, 0x3f803f80
    v_mov_b32 v21, 0x3f803f80
    v_mov_b32 v22, 0x3f803f80
    v_mov_b32 v23, 0x3f803f80
    v_mov_b32 v24, 0x3f803f80
    v_mov_b32 v25, 0x3f803f80
    v_mov_b32 v26, 0x3f803f80
    v_mov_b32 v27, 0x3f803f80
    v_mov_b32 v28, 0x3f803f80
    v_mov_b32 v29, 0x3f803f80
    v_mov_b32 v30, 0x3f803f80
    v_mov_b32 v31, 0x3f803f80
    v_bfe_u32 v10, v0, 2, 1
    v_mul_u32_u24 v10, 1280, v10
    v_lshrrev_b32 v63, 4, v0
    v_lshl_add_u32 v10, v63, 4, v10
    s_mul_i32 s70, s3, 320
    s_mov_b32 exec_lo, 0x00ff00ff
    s_mov_b32 exec_hi, 0x00ff00ff
    buffer_load_dwordx4 v[12:15], v10, s[36:39], s70 offen offset:0
    buffer_load_dwordx4 v[16:19], v10, s[36:39], s70 offen offset:64
    buffer_load_dwordx4 v[20:23], v10, s[36:39], s70 offen offset:128
    buffer_load_dwordx4 v[24:27], v10, s[36:39], s70 offen offset:192
    buffer_load_dwordx4 v[28:31], v10, s[36:39], s70 offen offset:256
    s_mov_b64 exec, -1
    v_lshrrev_b32 v62, 2, v0
    v_mul_u32_u24 v62, 12288, v62
    v_and_b32 v63, 3, v0
    v_lshl_add_u32 v62, v63, 4, v62
    s_mul_i32 s53, s3, 1966080
    s_mul_i32 s69, s58, 384
    s_add_u32 s53, s53, s69
    s_lshl_b32 s69, s57, 6
    s_add_u32 s53, s53, s69
    s_add_u32 m0, s66, 0
    s_nop 0
    buffer_load_dwordx4 v62, s[16:19], s53 offen sc1 nt lds
    s_add_u32 m0, s66, 1024
    s_add_u32 s53, s53, 196608
    buffer_load_dwordx4 v62, s[16:19], s53 offen sc1 nt lds
    s_add_u32 m0, s66, 2048
    s_add_u32 s53, s53, 196608
    buffer_load_dwordx4 v62, s[16:19], s53 offen sc1 nt lds
    s_add_u32 m0, s66, 3072
    s_add_u32 s53, s53, 196608
    buffer_load_dwordx4 v62, s[16:19], s53 offen sc1 nt lds
    s_add_u32 m0, s66, 4096
    s_add_u32 s53, s53, 196608
    buffer_load_dwordx4 v62, s[16:19], s53 offen sc1 nt lds
    s_add_u32 m0, s66, 5120
    s_add_u32 s53, s53, 196608
    buffer_load_dwordx4 v62, s[16:19], s53 offen sc1 nt lds
    s_add_u32 m0, s66, 6144
    s_add_u32 s53, s53, 196608
    buffer_load_dwordx4 v62, s[16:19], s53 offen sc1 nt lds
    s_add_u32 m0, s66, 7168
    s_add_u32 s53, s53, 196608
    buffer_load_dwordx4 v62, s[16:19], s53 offen sc1 nt lds
    s_add_u32 m0, s66, 8192
    s_add_u32 s53, s53, 196608
    buffer_load_dwordx4 v62, s[16:19], s53 offen sc1 nt lds
    s_add_u32 m0, s66, 9216
    s_add_u32 s53, s53, 196608
    buffer_load_dwordx4 v62, s[16:19], s53 offen sc1 nt lds
    s_cmp_eq_u32 s3, 3
    s_cbranch_scc0 L_nocnt_2
    s_waitcnt vmcnt(15)
    v_mov_b32 v62, 1
    v_mov_b32 v63, 0
    s_mov_b64 exec, 1
    buffer_atomic_add v62, v63, s[44:47], 0 offen sc1
    s_mov_b64 exec, -1
L_nocnt_2:
    buffer_load_dwordx4 a[64:67], v1, s[4:7], s48 offen offset:128 sc1 nt
    buffer_load_dwordx4 a[68:71], v1, s[4:7], s48 offen offset:256 sc1 nt
    s_add_u32 s48, s52, 18432
    buffer_load_dwordx4 a[72:75], v1, s[4:7], s48 offen offset:0 sc1 nt
    buffer_load_dwordx4 a[76:79], v1, s[4:7], s48 offen offset:128 sc1 nt
    buffer_load_dwordx4 a[80:83], v1, s[4:7], s48 offen offset:256 sc1 nt
    s_add_u32 s48, s52, 21504
    buffer_load_dwordx4 a[84:87], v1, s[4:7], s48 offen offset:0 sc1 nt
    buffer_load_dwordx4 a[88:91], v1, s[4:7], s48 offen offset:128 sc1 nt
    buffer_load_dwordx4 a[92:95], v1, s[4:7], s48 offen offset:256 sc1 nt
    s_add_u32 s48, s52, 24576
    buffer_load_dwordx4 a[96:99], v1, s[4:7], s48 offen offset:0 sc1 nt
    buffer_load_dwordx4 a[100:103], v1, s[4:7], s48 offen offset:128 sc1 nt
    buffer_load_dwordx4 a[104:107], v1, s[4:7], s48 offen offset:256 sc1 nt
    s_add_u32 s48, s52, 27648
    buffer_load_dwordx4 a[108:111], v1, s[4:7], s48 offen offset:0 sc1 nt
    buffer_load_dwordx4 a[112:115], v1, s[4:7], s48 offen offset:128 sc1 nt
    buffer_load_dwordx4 a[116:119], v1, s[4:7], s48 offen offset:256 sc1 nt
    s_add_u32 s48, s52, 30720
    buffer_load_dwordx4 a[120:123], v1, s[4:7], s48 offen offset:0 sc1 nt
    buffer_load_dwordx4 a[124:127], v1, s[4:7], s48 offen offset:128 sc1 nt
    buffer_load_dwordx4 a[128:131], v1, s[4:7], s48 offen offset:256 sc1 nt
    s_add_u32 s48, s52, 33792
    buffer_load_dwordx4 a[132:135], v1, s[4:7], s48 offen offset:0 sc1 nt
    buffer_load_dwordx4 a[136:139], v1, s[4:7], s48 offen offset:128 sc1 nt
    buffer_load_dwordx4 a[140:143], v1, s[4:7], s48 offen offset:256 sc1 nt
    s_add_u32 s48, s52, 36864
    buffer_load_dwordx4 a[144:147], v1, s[4:7], s48 offen offset:0 sc1 nt
    buffer_load_dwordx4 a[148:151], v1, s[4:7], s48 offen offset:128 sc1 nt
    buffer_load_dwordx4 a[152:155], v1, s[4:7], s48 offen offset:256 sc1 nt
    s_add_u32 s48, s52, 39936
    buffer_load_dwordx4 a[156:159], v1, s[4:7], s48 offen offset:0 sc1 nt
    buffer_load_dwordx4 a[160:163], v1, s[4:7], s48 offen offset:128 sc1 nt
    buffer_load_dwordx4 a[164:167], v1, s[4:7], s48 offen offset:256 sc1 nt
    s_add_u32 s48, s52, 43008
    buffer_load_dwordx4 a[168:171], v1, s[4:7], s48 offen offset:0 sc1 nt
    buffer_load_dwordx4 a[172:175], v1, s[4:7], s48 offen offset:128 sc1 nt
    s_waitcnt vmcnt(28)
    s_cmp_eq_u32 s72, 1
    s_cbranch_scc0 L_noq_3
    v_lshrrev_b32 v2, 4, v0
    v_lshlrev_b32 v2, 3, v2
    v_bfe_u32 v63, v0, 2, 2
    v_add_u32 v2, v2, v63
    v_mul_u32_u24 v2, 64, v2
    v_and_b32 v63, 3, v0
    v_lshl_add_u32 v2, v63, 3, v2
    v_add_u32 v2, s66, v2
    ds_read_b64_tr_b16 v[32:33], v2 offset:0
    ds_read_b64_tr_b16 v[34:35], v2 offset:256
    ds_read_b64_tr_b16 v[36:37], v2 offset:32
    ds_read_b64_tr_b16 v[38:39], v2 offset:288
    ds_read_b64_tr_b16 v[40:41], v2 offset:2048
    ds_read_b64_tr_b16 v[42:43], v2 offset:2304
    ds_read_b64_tr_b16 v[44:45], v2 offset:2080
    ds_read_b64_tr_b16 v[46:47], v2 offset:2336
    v_lshlrev_b32 v3, 4, v0
    s_lshl_b32 s53, s3, 2
    s_add_u32 s53, s53, 49152
    v_add_u32 v3, s53, v3
    v_lshrrev_b32 v4, 5, v0
    v_bfe_u32 v5, v0, 4, 1
    v_and_b32 v63, 15, v0
    v_lshlrev_b32 v6, 4, v63
    v_lshl_add_u32 v6, v5, 10, v6
    v_add_u32 v6, 49152, v6
    v_lshl_add_u32 v5, v4, 8, v6
    v_mul_u32_u24 v7, 320, v4
    v_add_u32 v7, 51200, v7
    v_lshlrev_b32 v8, 8, v4
    v_add_u32 v8, 51328, v8
    v_and_b32 v1, 31, v0
    v_lshlrev_b32 v1, 1, v1
    v_lshl_add_u32 v1, v4, 6, v1
    s_mul_i32 s69, s58, 6
    s_add_u32 s69, s69, s57
    s_lshl_b32 s69, s69, 7
    s_add_u32 s69, s69, s61
    s_waitcnt lgkmcnt(4)
    v_mfma_f32_16x16x32_bf16 v[56:59], v[12:15], v[12:15], 0
    v_mfma_f32_16x16x32_bf16 v[48:51], v[12:15], v[32:35], 0
    v_mfma_f32_16x16x32_bf16 v[52:55], v[12:15], v[36:39], 0
    ds_read_b64_tr_b16 v[32:33], v2 offset:4096
    ds_read_b64_tr_b16 v[34:35], v2 offset:4352
    ds_read_b64_tr_b16 v[36:37], v2 offset:4128
    ds_read_b64_tr_b16 v[38:39], v2 offset:4384
    s_waitcnt lgkmcnt(4)
    v_mfma_f32_16x16x32_bf16 v[56:59], v[16:19], v[16:19], v[56:59]
    v_mfma_f32_16x16x32_bf16 v[48:51], v[16:19], v[40:43], v[48:51]
    v_mfma_f32_16x16x32_bf16 v[52:55], v[16:19], v[44:47], v[52:55]
    ds_read_b64_tr_b16 v[40:41], v2 offset:6144
    ds_read_b64_tr_b16 v[42:43], v2 offset:6400
    ds_read_b64_tr_b16 v[44:45], v2 offset:6176
    ds_read_b64_tr_b16 v[46:47], v2 offset:6432
    s_waitcnt lgkmcnt(4)
    v_mfma_f32_16x16x32_bf16 v[56:59], v[20:23], v[20:23], v[56:59]
    v_mfma_f32_16x16x32_bf16 v[48:51], v[20:23], v[32:35], v[48:51]
    v_mfma_f32_16x16x32_bf16 v[52:55], v[20:23], v[36:39], v[52:55]
    ds_read_b64_tr_b16 v[32:33], v2 offset:8192
    ds_read_b64_tr_b16 v[34:35], v2 offset:8448
    ds_read_b64_tr_b16 v[36:37], v2 offset:8224
    ds_read_b64_tr_b16 v[38:39], v2 offset:8480
    s_waitcnt lgkmcnt(4)
    v_mfma_f32_16x16x32_bf16 v[56:59], v[24:27], v[24:27], v[56:59]
    v_mfma_f32_16x16x32_bf16 v[48:51], v[24:27], v[40:43], v[48:51]
    v_mfma_f32_16x16x32_bf16 v[52:55], v[24:27], v[44:47], v[52:55]
    s_waitcnt lgkmcnt(0)
    v_mfma_f32_16x16x32_bf16 v[56:59], v[28:31], v[28:31], v[56:59]
    v_mfma_f32_16x16x32_bf16 v[48:51], v[28:31], v[32:35], v[48:51]
    v_mfma_f32_16x16x32_bf16 v[52:55], v[28:31], v[36:39], v[52:55]
    s_nop 5
    ds_write_b32 v3, v56 offset:2048
    ds_write_b32 v3, v48
    ds_write_b32 v3, v52 offset:1024
    s_waitcnt lgkmcnt(0)
    s_barrier
    s_cmp_eq_u32 s3, 3
    s_cbranch_scc1 L_qfin_4
    s_barrier
    s_branch L_qjoin_5
L_qfin_4:
    ds_read_b128 v[20:23], v7
    ds_read_b128 v[24:27], v8
    ds_read_b128 v[12:15], v5
    ds_read_b128 v[16:19], v6 offset:512
    s_waitcnt lgkmcnt(0)
    v_pk_add_f32 v[20:21], v[20:21], v[22:23]
    v_pk_add_f32 v[24:25], v[24:25], v[26:27]
    v_pk_add_f32 v[12:13], v[12:13], v[14:15]
    v_pk_add_f32 v[16:17], v[16:17], v[18:19]
    v_add_f32 v20, v20, v21
    v_add_f32 v24, v24, v25
    v_add_f32 v12, v12, v13
    v_add_f32 v16, v16, v17
    v_mul_f32 v22, 0x3acccccd, v24
    v_mul_f32 v23, 0x3acccccd, v20
    v_fma_f32 v23, -v22, v22, v23
    v_max_f32 v23, 0, v23
    v_add_f32 v23, 0x3727c5ac, v23
    v_rsq_f32 v23, v23
    v_fma_f32 v12, -v22, v16, v12
    v_mul_f32 v12, v12, v23
    s_nop 1
    v_mov_b32_dpp v13, v12 quad_perm:[1,0,3,2] row_mask:0xf bank_mask:0xf
    v_cvt_pk_bf16_f32 v12, v12, v13
    v_min_u32 v12, -2, v12
    s_mov_b32 exec_lo, 0x55555555
    s_mov_b32 exec_hi, 0x55555555
    s_cmp_eq_u32 s87, 1
    s_cbranch_scc1 L_pfast_6
    buffer_store_dword v12, v1, s[12:15], s69 offen sc1
    s_branch L_pjoin_7
L_pfast_6:
    buffer_store_dword v12, v1, s[12:15], s69 offen
L_pjoin_7:
    s_mov_b64 exec, -1
    s_barrier
L_qjoin_5:
L_noq_3:
    v_and_b32 v1, 7, v0
    v_mul_u32_u24 v1, 384, v1
    v_bfe_u32 v63, v0, 3, 1
    v_lshl_add_u32 v1, v63, 6, v1
    v_lshrrev_b32 v62, 4, v0
    v_lshl_add_u32 v1, v62, 4, v1
    v_lshl_add_u32 v2, v63, 2, v62
    v_lshlrev_b32 v4, 2, v2
    v_mul_u32_u24 v2, 384, v2
    v_and_b32 v63, 7, v0
    v_lshl_add_u32 v2, v63, 4, v2
    v_lshlrev_b32 v3, 4, v0
    v_add_u32 v3, s67, v3
    v_and_b32 v62, 1, v0
    v_mov_b32 v9, 0xffff
    v_lshlrev_b32 v62, 4, v62
    v_lshlrev_b32 v9, v62, v9
    v_bfe_u32 v63, v0, 1, 2
    v_cmp_eq_u32 vcc, 0, v63
    s_nop 1
    v_cndmask_b32 v5, 0, v9, vcc
    v_cmp_eq_u32 vcc, 1, v63
    s_nop 1
    v_cndmask_b32 v6, 0, v9, vcc
    v_cmp_eq_u32 vcc, 2, v63
    s_nop 1
    v_cndmask_b32 v7, 0, v9, vcc
    v_cmp_eq_u32 vcc, 3, v63
    s_nop 1
    v_cndmask_b32 v8, 0, v9, vcc
    buffer_load_dwordx4 a[176:179], v1, s[4:7], s48 offen offset:256 sc1 nt
    s_add_u32 s48, s52, 46080
    buffer_load_dwordx4 a[180:183], v1, s[4:7], s48 offen offset:0 sc1 nt
    s_waitcnt vmcnt(31)
    buffer_load_dwordx4 a[184:187], v1, s[4:7], s48 offen offset:128 sc1 nt
    s_waitcnt vmcnt(31)
    buffer_load_dwordx4 a[188:191], v1, s[4:7], s48 offen offset:256 sc1 nt
    s_waitcnt vmcnt(31)
    s_add_u32 s48, s52, 49152
    buffer_load_dwordx4 a[192:195], v1, s[4:7], s48 offen offset:0 sc1 nt
    s_waitcnt vmcnt(31)
    buffer_load_dwordx4 a[196:199], v1, s[4:7], s48 offen offset:128 sc1 nt
    s_waitcnt vmcnt(31)
    buffer_load_dwordx4 a[200:203], v1, s[4:7], s48 offen offset:256 sc1 nt
    s_waitcnt vmcnt(31)
    s_add_u32 s48, s52, 52224
    buffer_load_dwordx4 a[204:207], v1, s[4:7], s48 offen offset:0 sc1 nt
    s_waitcnt vmcnt(31)
    buffer_load_dwordx4 a[208:211], v1, s[4:7], s48 offen offset:128 sc1 nt
    s_waitcnt vmcnt(31)
    buffer_load_dwordx4 a[212:215], v1, s[4:7], s48 offen offset:256 sc1 nt
    s_waitcnt vmcnt(31)
    s_add_u32 s48, s52, 55296
    buffer_load_dwordx4 a[216:219], v1, s[4:7], s48 offen offset:0 sc1 nt
    s_waitcnt vmcnt(31)
    buffer_load_dwordx4 a[220:223], v1, s[4:7], s48 offen offset:128 sc1 nt
    s_waitcnt vmcnt(31)
    buffer_load_dwordx4 a[224:227], v1, s[4:7], s48 offen offset:256 sc1 nt
    s_waitcnt vmcnt(31)
    s_add_u32 s48, s52, 58368
    buffer_load_dwordx4 a[228:231], v1, s[4:7], s48 offen offset:0 sc1 nt
    s_waitcnt vmcnt(31)
    buffer_load_dwordx4 a[232:235], v1, s[4:7], s48 offen offset:128 sc1 nt
    s_waitcnt vmcnt(31)
    buffer_load_dwordx4 a[236:239], v1, s[4:7], s48 offen offset:256 sc1 nt
    s_waitcnt vmcnt(31)
    s_add_u32 s48, s52, 61440
    buffer_load_dwordx4 a[240:243], v1, s[4:7], s48 offen offset:0 sc1 nt
    s_waitcnt vmcnt(31)
    buffer_load_dwordx4 a[244:247], v1, s[4:7], s48 offen offset:128 sc1 nt
    s_waitcnt vmcnt(31)
    buffer_load_dwordx4 a[248:251], v1, s[4:7], s48 offen offset:256 sc1 nt
    s_waitcnt vmcnt(31)
    s_add_u32 s48, s52, 64512
    buffer_load_dwordx4 a[252:255], v1, s[4:7], s48 offen offset:0 sc1 nt
    s_waitcnt vmcnt(31)
    buffer_load_dwordx4 v[64:67], v1, s[4:7], s48 offen offset:128 sc1 nt
    s_waitcnt vmcnt(31)
    buffer_load_dwordx4 v[68:71], v1, s[4:7], s48 offen offset:256 sc1 nt
    s_waitcnt vmcnt(31)
    s_add_u32 s48, s52, 67584
    buffer_load_dwordx4 v[72:75], v1, s[4:7], s48 offen offset:0 sc1 nt
    s_waitcnt vmcnt(31)
    buffer_load_dwordx4 v[76:79], v1, s[4:7], s48 offen offset:128 sc1 nt
    s_waitcnt vmcnt(31)
    buffer_load_dwordx4 v[80:83], v1, s[4:7], s48 offen offset:256 sc1 nt
    s_waitcnt vmcnt(31)
    s_add_u32 s48, s52, 70656
    buffer_load_dwordx4 v[84:87], v1, s[4:7], s48 offen offset:0 sc1 nt
    s_waitcnt vmcnt(31)
    buffer_load_dwordx4 v[88:91], v1, s[4:7], s48 offen offset:128 sc1 nt
    s_waitcnt vmcnt(31)
    buffer_load_dwordx4 v[92:95], v1, s[4:7], s48 offen offset:256 sc1 nt
    s_waitcnt vmcnt(31)
    s_add_u32 s48, s52, 73728
    buffer_load_dwordx4 v[96:99], v1, s[4:7], s48 offen offset:0 sc1 nt
    s_waitcnt vmcnt(31)
    buffer_load_dwordx4 v[100:103], v1, s[4:7], s48 offen offset:128 sc1 nt
    s_waitcnt vmcnt(31)
    buffer_load_dwordx4 v[104:107], v1, s[4:7], s48 offen offset:256 sc1 nt
    s_waitcnt vmcnt(31)
    s_add_u32 s48, s52, 76800
    buffer_load_dwordx4 v[108:111], v1, s[4:7], s48 offen offset:0 sc1 nt
    s_waitcnt vmcnt(31)
    buffer_load_dwordx4 v[112:115], v1, s[4:7], s48 offen offset:128 sc1 nt
    s_waitcnt vmcnt(31)
    buffer_load_dwordx4 v[116:119], v1, s[4:7], s48 offen offset:256 sc1 nt
    v_mov_b32 v10, 0
    buffer_load_dword v9, v10, s[44:47], 0 offen sc1
    s_waitcnt vmcnt(31)
    s_add_u32 s48, s52, 79872
    buffer_load_dwordx4 v[120:123], v1, s[4:7], s48 offen offset:0 sc1 nt
    s_waitcnt vmcnt(31)
    buffer_load_dwordx4 v[124:127], v1, s[4:7], s48 offen offset:128 sc1 nt
    s_waitcnt vmcnt(31)
    buffer_load_dwordx4 v[128:131], v1, s[4:7], s48 offen offset:256 sc1 nt
    s_waitcnt vmcnt(31)
    s_add_u32 s48, s52, 82944
    buffer_load_dwordx4 v[132:135], v1, s[4:7], s48 offen offset:0 sc1 nt
    s_waitcnt vmcnt(31)
    buffer_load_dwordx4 v[136:139], v1, s[4:7], s48 offen offset:128 sc1 nt
    s_waitcnt vmcnt(31)
    buffer_load_dwordx4 v[140:143], v1, s[4:7], s48 offen offset:256 sc1 nt
    s_waitcnt vmcnt(31)
    s_add_u32 s48, s52, 86016
    buffer_load_dwordx4 v[144:147], v1, s[4:7], s48 offen offset:0 sc1 nt
    s_waitcnt vmcnt(31)
    buffer_load_dwordx4 v[148:151], v1, s[4:7], s48 offen offset:128 sc1 nt
    s_waitcnt vmcnt(31)
    buffer_load_dwordx4 v[152:155], v1, s[4:7], s48 offen offset:256 sc1 nt
    s_waitcnt vmcnt(31)
    s_add_u32 s48, s52, 89088
    buffer_load_dwordx4 v[156:159], v1, s[4:7], s48 offen offset:0 sc1 nt
    s_waitcnt vmcnt(31)
    buffer_load_dwordx4 v[160:163], v1, s[4:7], s48 offen offset:128 sc1 nt
    s_waitcnt vmcnt(31)
    buffer_load_dwordx4 v[164:167], v1, s[4:7], s48 offen offset:256 sc1 nt
    s_waitcnt vmcnt(12)
    v_cmp_gt_u32 vcc, 256, v9
    s_nop 4
    s_cbranch_vccz L_ctr_ok_8
    s_mov_b32 s68, 0
L_ctr_spin_9:
    buffer_load_dword v9, v10, s[44:47], 0 offen sc1
    s_waitcnt vmcnt(0)
    v_cmp_gt_u32 vcc, 256, v9
    s_nop 4
    s_cbranch_vccz L_ctr_ok_8
    s_add_u32 s68, s68, 1
    s_cmp_lt_u32 s68, s77
    s_cbranch_scc1 L_ctr_spin_9
    s_mov_b32 s77, 0
L_ctr_ok_8:
    v_and_b32 v10, 31, v0
    v_lshlrev_b32 v10, 5, v10
    s_lshl_b32 s69, s54, 2
    s_add_u32 s69, s69, 212992
    buffer_load_dword v9, v10, s[12:15], s69 offen sc1
    v_and_b32 v10, 1, v0
    v_lshlrev_b32 v10, 7, v10
    v_lshrrev_b32 v63, 4, v0
    v_lshl_add_u32 v10, v63, 4, v10
    s_mul_i32 s70, s58, 768
    s_lshl_b32 s69, s59, 6
    s_add_u32 s70, s70, s69
    s_add_u32 s70, s70, s61
    buffer_load_dwordx4 v[12:15], v10, s[12:15], s70 offen offset:0 sc1
    buffer_load_dwordx4 v[16:19], v10, s[12:15], s70 offen offset:256 sc1
    buffer_load_dwordx4 v[20:23], v10, s[12:15], s70 offen offset:512 sc1
    s_add_u32 s48, s52, 92160
    buffer_load_dwordx4 v[168:171], v1, s[4:7], s48 offen offset:0 sc1 nt
    buffer_load_dwordx4 v[172:175], v1, s[4:7], s48 offen offset:128 sc1 nt
    buffer_load_dwordx4 v[176:179], v1, s[4:7], s48 offen offset:256 sc1 nt
    s_add_u32 s48, s52, 95232
    buffer_load_dwordx4 v[180:183], v1, s[4:7], s48 offen offset:0 sc1 nt
    buffer_load_dwordx4 v[184:187], v1, s[4:7], s48 offen offset:128 sc1 nt
    buffer_load_dwordx4 v[188:191], v1, s[4:7], s48 offen offset:256 sc1 nt
    s_add_u32 s71, s52, 0
    buffer_load_dwordx4 v[192:195], v2, s[8:11], s71 offen offset:0 sc1 nt
    buffer_load_dwordx4 v[196:199], v2, s[8:11], s71 offen offset:128 sc1 nt
    buffer_load_dwordx4 v[200:203], v2, s[8:11], s71 offen offset:256 sc1 nt
    s_add_u32 s71, s52, 3072
    buffer_load_dwordx4 v[204:207], v2, s[8:11], s71 offen offset:0 sc1 nt
    buffer_load_dwordx4 v[208:211], v2, s[8:11], s71 offen offset:128 sc1 nt
    buffer_load_dwordx4 v[212:215], v2, s[8:11], s71 offen offset:256 sc1 nt
    s_add_u32 s71, s52, 6144
    buffer_load_dwordx4 v[216:219], v2, s[8:11], s71 offen offset:0 sc1 nt
    buffer_load_dwordx4 v[220:223], v2, s[8:11], s71 offen offset:128 sc1 nt
    buffer_load_dwordx4 v[224:227], v2, s[8:11], s71 offen offset:256 sc1 nt
    s_add_u32 s71, s52, 9216
    buffer_load_dwordx4 v[228:231], v2, s[8:11], s71 offen offset:0 sc1 nt
    s_waitcnt vmcnt(31)
    buffer_load_dwordx4 v[232:235], v2, s[8:11], s71 offen offset:128 sc1 nt
    s_waitcnt vmcnt(31)
    buffer_load_dwordx4 v[236:239], v2, s[8:11], s71 offen offset:256 sc1 nt
    s_waitcnt vmcnt(18)
    v_cmp_ne_u32 vcc, s86, v9
    s_nop 0
    s_cmp_eq_u64 vcc, 0
    s_cselect_b32 s87, 1, 0
    v_max3_u32 v63, v12, v13, v14
    v_max3_u32 v63, v15, v16, v63
    v_max3_u32 v63, v17, v18, v63
    v_max3_u32 v63, v19, v20, v63
    v_max3_u32 v63, v21, v22, v63
    v_max_u32 v63, v23, v63
    v_cmp_eq_u32 vcc, -1, v63
    s_nop 4
    s_cbranch_vccz L_q_ok_10
    v_and_b32 v10, 1, v0
    v_lshlrev_b32 v10, 7, v10
    v_lshrrev_b32 v63, 4, v0
    v_lshl_add_u32 v10, v63, 4, v10
    s_mul_i32 s70, s58, 768
    s_lshl_b32 s69, s59, 6
    s_add_u32 s70, s70, s69
    s_add_u32 s70, s70, s61
    s_mov_b32 s68, 0
L_q1_poll_11:
    buffer_load_dwordx4 v[12:15], v10, s[12:15], s70 offen offset:0 sc1
    buffer_load_dwordx4 v[16:19], v10, s[12:15], s70 offen offset:256 sc1
    buffer_load_dwordx4 v[20:23], v10, s[12:15], s70 offen offset:512 sc1
    s_waitcnt vmcnt(0)
    v_max3_u32 v63, v12, v13, v14
    v_max3_u32 v63, v15, v16, v63
    v_max3_u32 v63, v17, v18, v63
    v_max3_u32 v63, v19, v20, v63
    v_max3_u32 v63, v21, v22, v63
    v_max_u32 v63, v23, v63
    v_cmp_eq_u32 vcc, -1, v63
    s_nop 1
    s_cbranch_vccz L_q1_ok_12
    s_add_u32 s68, s68, 1
    s_cmp_lt_u32 s68, s77
    s_nop 1
    s_cbranch_scc1 L_q1_poll_11
    s_mov_b32 s77, 0
L_q1_ok_12:
L_q_ok_10:
    s_waitcnt vmcnt(12)
    v_mfma_f32_16x16x32_bf16 v[24:27], v[12:15], a[0:3], 0
    v_mfma_f32_16x16x32_bf16 v[24:27], v[16:19], a[4:7], v[24:27]
    v_mfma_f32_16x16x32_bf16 v[24:27], v[20:23], a[8:11], v[24:27]
    s_add_u32 s71, s52, 12288
    buffer_load_dwordx4 v[240:243], v2, s[8:11], s71 offen offset:0 sc1 nt
    v_mfma_f32_16x16x32_bf16 v[28:31], v[12:15], a[12:15], 0
    v_mfma_f32_16x16x32_bf16 v[28:31], v[16:19], a[16:19], v[28:31]
    v_mfma_f32_16x16x32_bf16 v[28:31], v[20:23], a[20:23], v[28:31]
    buffer_load_dwordx4 v[244:247], v2, s[8:11], s71 offen offset:128 sc1 nt
    v_mfma_f32_16x16x32_bf16 v[52:55], v[12:15], a[24:27], 0
    v_mfma_f32_16x16x32_bf16 v[52:55], v[16:19], a[28:31], v[52:55]
    v_mfma_f32_16x16x32_bf16 v[52:55], v[20:23], a[32:35], v[52:55]
    buffer_load_dwordx4 v[248:251], v2, s[8:11], s71 offen offset:256 sc1 nt
    v_add_f32_dpp v32, v25, v24 row_ror:8 row_mask:0x1 bank_mask:0x3
    v_mfma_f32_16x16x32_bf16 v[24:27], v[12:15], a[36:39], 0
    v_mfma_f32_16x16x32_bf16 v[24:27], v[16:19], a[40:43], v[24:27]
    v_mfma_f32_16x16x32_bf16 v[24:27], v[20:23], a[44:47], v[24:27]
    s_add_u32 s71, s52, 15360
    buffer_load_dwordx4 v[252:255], v2, s[8:11], s71 offen offset:0 sc1 nt
    v_add_f32_dpp v32, v28, v29 row_ror:8 row_mask:0x1 bank_mask:0xc
    v_mfma_f32_16x16x32_bf16 v[28:31], v[12:15], a[48:51], 0
    v_mfma_f32_16x16x32_bf16 v[28:31], v[16:19], a[52:55], v[28:31]
    v_mfma_f32_16x16x32_bf16 v[28:31], v[20:23], a[56:59], v[28:31]
    s_add_u32 m0, s67, 4294967168
    s_nop 0
    buffer_load_dwordx4 v2, s[8:11], s71 offen offset:128 sc1 nt lds
    v_add_f32_dpp v32, v53, v52 row_ror:8 row_mask:0x2 bank_mask:0x3
    v_mfma_f32_16x16x32_bf16 v[52:55], v[12:15], a[60:63], 0
    v_mfma_f32_16x16x32_bf16 v[52:55], v[16:19], a[64:67], v[52:55]
    v_mfma_f32_16x16x32_bf16 v[52:55], v[20:23], a[68:71], v[52:55]
    s_add_u32 m0, s67, 768
    s_nop 0
    buffer_load_dwordx4 v2, s[8:11], s71 offen offset:256 sc1 nt lds
    v_add_f32_dpp v32, v24, v25 row_ror:8 row_mask:0x2 bank_mask:0xc
    v_mfma_f32_16x16x32_bf16 v[24:27], v[12:15], a[72:75], 0
    v_mfma_f32_16x16x32_bf16 v[24:27], v[16:19], a[76:79], v[24:27]
    v_mfma_f32_16x16x32_bf16 v[24:27], v[20:23], a[80:83], v[24:27]
    s_add_u32 s71, s52, 18432
    s_add_u32 m0, s67, 2048
    s_nop 0
    buffer_load_dwordx4 v2, s[8:11], s71 offen offset:0 sc1 nt lds
    v_add_f32_dpp v32, v29, v28 row_ror:8 row_mask:0x4 bank_mask:0x3
    v_mfma_f32_16x16x32_bf16 v[28:31], v[12:15], a[84:87], 0
    v_mfma_f32_16x16x32_bf16 v[28:31], v[16:19], a[88:91], v[28:31]
    v_mfma_f32_16x16x32_bf16 v[28:31], v[20:23], a[92:95], v[28:31]
    s_add_u32 m0, s67, 2944
    s_nop 0
    buffer_load_dwordx4 v2, s[8:11], s71 offen offset:128 sc1 nt lds
    v_add_f32_dpp v32, v52, v53 row_ror:8 row_mask:0x4 bank_mask:0xc
    v_mfma_f32_16x16x32_bf16 v[52:55], v[12:15], a[96:99], 0
    v_mfma_f32_16x16x32_bf16 v[52:55], v[16:19], a[100:103], v[52:55]
    v_mfma_f32_16x16x32_bf16 v[52:55], v[20:23], a[104:107], v[52:55]
    s_add_u32 m0, s67, 3840
    s_nop 0
    buffer_load_dwordx4 v2, s[8:11], s71 offen offset:256 sc1 nt lds
    v_add_f32_dpp v32, v25, v24 row_ror:8 row_mask:0x8 bank_mask:0x3
    v_mfma_f32_16x16x32_bf16 v[24:27], v[12:15], a[108:111], 0
    v_mfma_f32_16x16x32_bf16 v[24:27], v[16:19], a[112:115], v[24:27]
    v_mfma_f32_16x16x32_bf16 v[24:27], v[20:23], a[116:119], v[24:27]
    s_add_u32 s71, s52, 21504
    s_add_u32 m0, s67, 5120
    s_nop 0
    buffer_load_dwordx4 v2, s[8:11], s71 offen offset:0 sc1 nt lds
    v_add_f32_dpp v32, v28, v29 row_ror:8 row_mask:0x8 bank_mask:0xc
    v_mfma_f32_16x16x32_bf16 v[28:31], v[12:15], a[120:123], 0
    v_mfma_f32_16x16x32_bf16 v[28:31], v[16:19], a[124:127], v[28:31]
    v_mfma_f32_16x16x32_bf16 v[28:31], v[20:23], a[128:131], v[28:31]
    s_add_u32 m0, s67, 6016
    s_nop 0
    buffer_load_dwordx4 v2, s[8:11], s71 offen offset:128 sc1 nt lds
    v_add_f32_dpp v33, v53, v52 row_ror:8 row_mask:0x1 bank_mask:0x3
    v_mfma_f32_16x16x32_bf16 v[52:55], v[12:15], a[132:135], 0
    v_mfma_f32_16x16x32_bf16 v[52:55], v[16:19], a[136:139], v[52:55]
    v_mfma_f32_16x16x32_bf16 v[52:55], v[20:23], a[140:143], v[52:55]
    s_add_u32 m0, s67, 6912
    s_nop 0
    buffer_load_dwordx4 v2, s[8:11], s71 offen offset:256 sc1 nt lds
    v_add_f32_dpp v33, v24, v25 row_ror:8 row_mask:0x1 bank_mask:0xc
    v_mfma_f32_16x16x32_bf16 v[24:27], v[12:15], a[144:147], 0
    v_mfma_f32_16x16x32_bf16 v[24:27], v[16:19], a[148:151], v[24:27]
    v_mfma_f32_16x16x32_bf16 v[24:27], v[20:23], a[152:155], v[24:27]
    s_add_u32 s71, s52, 24576
    s_add_u32 m0, s67, 8192
    s_nop 0
    buffer_load_dwordx4 v2, s[8:11], s71 offen offset:0 sc1 nt lds
    v_add_f32_dpp v33, v29, v28 row_ror:8 row_mask:0x2 bank_mask:0x3
    v_mfma_f32_16x16x32_bf16 v[28:31], v[12:15], a[156:159], 0
    v_mfma_f32_16x16x32_bf16 v[28:31], v[16:19], a[160:163], v[28:31]
    v_mfma_f32_16x16x32_bf16 v[28:31], v[20:23], a[164:167], v[28:31]
    s_add_u32 m0, s67, 9088
    s_nop 0
    buffer_load_dwordx4 v2, s[8:11], s71 offen offset:128 sc1 nt lds
    v_add_f32_dpp v33, v52, v53 row_ror:8 row_mask:0x2 bank_mask:0xc
    v_mfma_f32_16x16x32_bf16 v[52:55], v[12:15], a[168:171], 0
    v_mfma_f32_16x16x32_bf16 v[52:55], v[16:19], a[172:175], v[52:55]
    v_mfma_f32_16x16x32_bf16 v[52:55], v[20:23], a[176:179], v[52:55]
    s_add_u32 m0, s67, 9984
    s_nop 0
    buffer_load_dwordx4 v2, s[8:11], s71 offen offset:256 sc1 nt lds
    v_add_f32_dpp v33, v25, v24 row_ror:8 row_mask:0x4 bank_mask:0x3
    v_mfma_f32_16x16x32_bf16 v[24:27], v[12:15], a[180:183], 0
    v_mfma_f32_16x16x32_bf16 v[24:27], v[16:19], a[184:187], v[24:27]
    v_mfma_f32_16x16x32_bf16 v[24:27], v[20:23], a[188:191], v[24:27]
    s_add_u32 s71, s52, 27648
    s_add_u32 m0, s67, 11264
    s_nop 0
    buffer_load_dwordx4 v2, s[8:11], s71 offen offset:0 sc1 nt lds
    v_add_f32_dpp v33, v28, v29 row_ror:8 row_mask:0x4 bank_mask:0xc
    v_mfma_f32_16x16x32_bf16 v[28:31], v[12:15], a[192:195], 0
    v_mfma_f32_16x16x32_bf16 v[28:31], v[16:19], a[196:199], v[28:31]
    v_mfma_f32_16x16x32_bf16 v[28:31], v[20:23], a[200:203], v[28:31]
    s_add_u32 m0, s67, 12160
    s_nop 0
    buffer_load_dwordx4 v2, s[8:11], s71 offen offset:128 sc1 nt lds
    v_add_f32_dpp v33, v53, v52 row_ror:8 row_mask:0x8 bank_mask:0x3
    v_mfma_f32_16x16x32_bf16 v[52:55], v[12:15], a[204:207], 0
    v_mfma_f32_16x16x32_bf16 v[52:55], v[16:19], a[208:211], v[52:55]
    v_mfma_f32_16x16x32_bf16 v[52:55], v[20:23], a[212:215], v[52:55]
    s_add_u32 m0, s67, 13056
    s_nop 0
    buffer_load_dwordx4 v2, s[8:11], s71 offen offset:256 sc1 nt lds
    v_add_f32_dpp v33, v24, v25 row_ror:8 row_mask:0x8 bank_mask:0xc
    v_mfma_f32_16x16x32_bf16 v[24:27], v[12:15], a[216:219], 0
    v_mfma_f32_16x16x32_bf16 v[24:27], v[16:19], a[220:223], v[24:27]
    v_mfma_f32_16x16x32_bf16 v[24:27], v[20:23], a[224:227], v[24:27]
    s_add_u32 s71, s52, 30720
    s_add_u32 m0, s67, 14336
    s_nop 0
    buffer_load_dwordx4 v2, s[8:11], s71 offen offset:0 sc1 nt lds
    v_add_f32_dpp v34, v29, v28 row_ror:8 row_mask:0x1 bank_mask:0x3
    v_mfma_f32_16x16x32_bf16 v[28:31], v[12:15], a[228:231], 0
    v_mfma_f32_16x16x32_bf16 v[28:31], v[16:19], a[232:235], v[28:31]
    v_mfma_f32_16x16x32_bf16 v[28:31], v[20:23], a[236:239], v[28:31]
    s_add_u32 m0, s67, 15232
    s_nop 0
    buffer_load_dwordx4 v2, s[8:11], s71 offen offset:128 sc1 nt lds
    v_add_f32_dpp v34, v52, v53 row_ror:8 row_mask:0x1 bank_mask:0xc
    v_mfma_f32_16x16x32_bf16 v[52:55], v[12:15], a[240:243], 0
    v_mfma_f32_16x16x32_bf16 v[52:55], v[16:19], a[244:247], v[52:55]
    v_mfma_f32_16x16x32_bf16 v[52:55], v[20:23], a[248:251], v[52:55]
    s_add_u32 m0, s67, 16128
    s_nop 0
    buffer_load_dwordx4 v2, s[8:11], s71 offen offset:256 sc1 nt lds
    v_add_f32_dpp v34, v25, v24 row_ror:8 row_mask:0x2 bank_mask:0x3
    v_mfma_f32_16x16x32_bf16 v[24:27], v[12:15], a[252:255], 0
    v_mfma_f32_16x16x32_bf16 v[24:27], v[16:19], v[64:67], v[24:27]
    v_mfma_f32_16x16x32_bf16 v[24:27], v[20:23], v[68:71], v[24:27]
    s_add_u32 s71, s52, 33792
    s_add_u32 m0, s67, 17408
    s_nop 0
    buffer_load_dwordx4 v2, s[8:11], s71 offen offset:0 lds
    v_add_f32_dpp v34, v28, v29 row_ror:8 row_mask:0x2 bank_mask:0xc
    v_mfma_f32_16x16x32_bf16 v[28:31], v[12:15], v[72:75], 0
    v_mfma_f32_16x16x32_bf16 v[28:31], v[16:19], v[76:79], v[28:31]
    v_mfma_f32_16x16x32_bf16 v[28:31], v[20:23], v[80:83], v[28:31]
    s_add_u32 m0, s67, 18304
    s_nop 0
    buffer_load_dwordx4 v2, s[8:11], s71 offen offset:128 lds
    v_add_f32_dpp v34, v53, v52 row_ror:8 row_mask:0x4 bank_mask:0x3
    v_mfma_f32_16x16x32_bf16 v[52:55], v[12:15], v[84:87], 0
    v_mfma_f32_16x16x32_bf16 v[52:55], v[16:19], v[88:91], v[52:55]
    v_mfma_f32_16x16x32_bf16 v[52:55], v[20:23], v[92:95], v[52:55]
    s_add_u32 m0, s67, 19200
    s_nop 0
    buffer_load_dwordx4 v2, s[8:11], s71 offen offset:256 lds
    v_add_f32_dpp v34, v24, v25 row_ror:8 row_mask:0x4 bank_mask:0xc
    v_mfma_f32_16x16x32_bf16 v[24:27], v[12:15], v[96:99], 0
    v_mfma_f32_16x16x32_bf16 v[24:27], v[16:19], v[100:103], v[24:27]
    v_mfma_f32_16x16x32_bf16 v[24:27], v[20:23], v[104:107], v[24:27]
    s_add_u32 s71, s52, 36864
    s_add_u32 m0, s67, 20480
    s_nop 0
    buffer_load_dwordx4 v2, s[8:11], s71 offen offset:0 lds
    v_add_f32_dpp v34, v29, v28 row_ror:8 row_mask:0x8 bank_mask:0x3
    v_mfma_f32_16x16x32_bf16 v[28:31], v[12:15], v[108:111], 0
    v_mfma_f32_16x16x32_bf16 v[28:31], v[16:19], v[112:115], v[28:31]
    v_mfma_f32_16x16x32_bf16 v[28:31], v[20:23], v[116:119], v[28:31]
    s_add_u32 m0, s67, 21376
    s_nop 0
    buffer_load_dwordx4 v2, s[8:11], s71 offen offset:128 lds
    v_add_f32_dpp v34, v52, v53 row_ror:8 row_mask:0x8 bank_mask:0xc
    v_mfma_f32_16x16x32_bf16 v[52:55], v[12:15], v[120:123], 0
    v_mfma_f32_16x16x32_bf16 v[52:55], v[16:19], v[124:127], v[52:55]
    v_mfma_f32_16x16x32_bf16 v[52:55], v[20:23], v[128:131], v[52:55]
    s_add_u32 m0, s67, 22272
    s_nop 0
    buffer_load_dwordx4 v2, s[8:11], s71 offen offset:256 lds
    v_add_f32_dpp v35, v25, v24 row_ror:8 row_mask:0x1 bank_mask:0x3
    v_mfma_f32_16x16x32_bf16 v[24:27], v[12:15], v[132:135], 0
    v_mfma_f32_16x16x32_bf16 v[24:27], v[16:19], v[136:139], v[24:27]
    v_mfma_f32_16x16x32_bf16 v[24:27], v[20:23], v[140:143], v[24:27]
    s_add_u32 s71, s52, 39936
    s_add_u32 m0, s67, 23552
    s_nop 0
    buffer_load_dwordx4 v2, s[8:11], s71 offen offset:0 lds
    v_add_f32_dpp v35, v28, v29 row_ror:8 row_mask:0x1 bank_mask:0xc
    v_mfma_f32_16x16x32_bf16 v[28:31], v[12:15], v[144:147], 0
    v_mfma_f32_16x16x32_bf16 v[28:31], v[16:19], v[148:151], v[28:31]
    v_mfma_f32_16x16x32_bf16 v[28:31], v[20:23], v[152:155], v[28:31]
    s_add_u32 m0, s67, 24448
    s_nop 0
    buffer_load_dwordx4 v2, s[8:11], s71 offen offset:128 lds
    v_add_f32_dpp v35, v53, v52 row_ror:8 row_mask:0x2 bank_mask:0x3
    v_mfma_f32_16x16x32_bf16 v[52:55], v[12:15], v[156:159], 0
    v_mfma_f32_16x16x32_bf16 v[52:55], v[16:19], v[160:163], v[52:55]
    v_mfma_f32_16x16x32_bf16 v[52:55], v[20:23], v[164:167], v[52:55]
    s_add_u32 m0, s67, 25344
    s_nop 0
    buffer_load_dwordx4 v2, s[8:11], s71 offen offset:256 lds
    v_add_f32_dpp v35, v24, v25 row_ror:8 row_mask:0x2 bank_mask:0xc
    v_mfma_f32_16x16x32_bf16 v[24:27], v[12:15], v[168:171], 0
    v_mfma_f32_16x16x32_bf16 v[24:27], v[16:19], v[172:175], v[24:27]
    v_mfma_f32_16x16x32_bf16 v[24:27], v[20:23], v[176:179], v[24:27]
    s_add_u32 s71, s52, 43008
    s_add_u32 m0, s67, 26624
    s_nop 0
    buffer_load_dwordx4 v2, s[8:11], s71 offen offset:0 lds
    v_add_f32_dpp v35, v29, v28 row_ror:8 row_mask:0x4 bank_mask:0x3
    v_mfma_f32_16x16x32_bf16 v[28:31], v[12:15], v[180:183], 0
    v_mfma_f32_16x16x32_bf16 v[28:31], v[16:19], v[184:187], v[28:31]
    v_mfma_f32_16x16x32_bf16 v[28:31], v[20:23], v[188:191], v[28:31]
    v_add_f32_dpp v35, v52, v53 row_ror:8 row_mask:0x4 bank_mask:0xc
    s_nop 1
    v_add_f32_dpp v35, v25, v24 row_ror:8 row_mask:0x8 bank_mask:0x3
    s_nop 3
    v_add_f32_dpp v35, v28, v29 row_ror:8 row_mask:0x8 bank_mask:0xc
    v_max3_f32 v62, v32, v33, v34
    v_max_f32 v62, v62, v35
    s_nop 1
    v_max_f32_dpp v62, v62, v62 row_ror:8 row_mask:0xf bank_mask:0xf
    s_nop 1
    v_max_f32_dpp v62, v62, v62 row_ror:4 row_mask:0xf bank_mask:0xf
    s_nop 1
    v_max_f32_dpp v62, v62, v62 row_ror:2 row_mask:0xf bank_mask:0xf
    s_nop 1
    v_max_f32_dpp v62, v62, v62 row_ror:1 row_mask:0xf bank_mask:0xf
    v_mov_b32 v63, v62
    s_nop 1
    v_permlane16_swap_b32 v62, v63
    v_max_f32 v62, v62, v63
    v_mov_b32 v63, v62
    s_nop 1
    v_permlane32_swap_b32 v62, v63
    v_max_f32 v62, v62, v63
    s_lshl_b32 s53, s3, 2
    s_add_u32 s53, s53, 52224
    v_mov_b32 v9, s53
    ds_write_b32 v9, v62
    v_mov_b32 v63, 52224
    s_waitcnt lgkmcnt(0)
    s_barrier
    ds_read_b128 v[12:15], v63
    s_mov_b32 s53, 0x3dd53b95
    s_waitcnt lgkmcnt(0)
    v_max3_f32 v62, v12, v13, v14
    v_max_f32 v62, v62, v15
    v_mul_f32 v11, s53, v62
    v_fma_f32 v32, v32, s53, -v11
    v_fma_f32 v33, v33, s53, -v11
    v_fma_f32 v34, v34, s53, -v11
    v_fma_f32 v35, v35, s53, -v11
    v_exp_f32 v32, v32
    v_exp_f32 v33, v33
    v_exp_f32 v34, v34
    v_exp_f32 v35, v35
    v_cvt_pk_bf16_f32 v36, v32, v32
    v_cvt_pk_bf16_f32 v37, v33, v33
    v_cvt_pk_bf16_f32 v38, v34, v34
    v_cvt_pk_bf16_f32 v39, v35, v35
    v_add_f32 v62, v32, v33
    v_add_f32 v63, v34, v35
    v_add_f32 v62, v62, v63
    s_nop 1
    v_add_f32_dpp v62, v62, v62 row_ror:8 row_mask:0xf bank_mask:0xf
    s_nop 1
    v_add_f32_dpp v62, v62, v62 row_ror:4 row_mask:0xf bank_mask:0xf
    s_nop 1
    v_add_f32_dpp v62, v62, v62 row_ror:2 row_mask:0xf bank_mask:0xf
    s_nop 1
    v_add_f32_dpp v62, v62, v62 row_ror:1 row_mask:0xf bank_mask:0xf
    v_mov_b32 v63, v62
    s_nop 1
    v_permlane16_swap_b32 v62, v63
    v_add_f32 v62, v62, v63
    v_mov_b32 v63, v62
    s_nop 1
    v_permlane32_swap_b32 v62, v63
    v_add_f32 v62, v62, v63
    ds_write_b32 v9, v62 offset:64
    v_bfe_u32 v9, v0, 4, 1
    v_and_b32 v63, 7, v0
    v_lshl_add_u32 v9, v9, 3, v63
    v_lshlrev_b32 v9, 4, v9
    v_lshrrev_b32 v63, 5, v0
    v_lshl_add_u32 v9, v63, 2, v9
    s_mul_i32 s53, s3, 768
    s_add_u32 s53, s53, 49152
    v_add_u32 v9, s53, v9
    ds_bpermute_b32 v60, v4, v36 offset:0
    s_waitcnt lgkmcnt(0)
    v_and_b32 v52, v60, v5
    v_and_b32 v53, v60, v6
    v_and_b32 v54, v60, v7
    v_and_b32 v55, v60, v8
    ds_bpermute_b32 v61, v4, v36 offset:32
    s_waitcnt vmcnt(42)
    v_mfma_f32_16x16x32_bf16 v[40:43], v[192:195], v[52:55], 0
    s_waitcnt vmcnt(41)
    v_mfma_f32_16x16x32_bf16 v[44:47], v[196:199], v[52:55], 0
    s_waitcnt vmcnt(40)
    v_mfma_f32_16x16x32_bf16 v[48:51], v[200:203], v[52:55], 0
    buffer_load_dwordx4 v[192:195], v2, s[8:11], s71 offen offset:128
    buffer_load_dwordx4 v[196:199], v2, s[8:11], s71 offen offset:256
    s_add_u32 s71, s52, 46080
    buffer_load_dwordx4 v[200:203], v2, s[8:11], s71 offen offset:0
    s_waitcnt lgkmcnt(0)
    v_and_b32 v56, v61, v5
    v_and_b32 v57, v61, v6
    v_and_b32 v58, v61, v7
    v_and_b32 v59, v61, v8
    ds_bpermute_b32 v60, v4, v36 offset:64
    s_waitcnt vmcnt(42)
    v_mfma_f32_16x16x32_bf16 v[40:43], v[204:207], v[56:59], v[40:43]
    s_waitcnt vmcnt(41)
    v_mfma_f32_16x16x32_bf16 v[44:47], v[208:211], v[56:59], v[44:47]
    s_waitcnt vmcnt(40)
    v_mfma_f32_16x16x32_bf16 v[48:51], v[212:215], v[56:59], v[48:51]
    buffer_load_dwordx4 v[204:207], v2, s[8:11], s71 offen offset:128
    buffer_load_dwordx4 v[208:211], v2, s[8:11], s71 offen offset:256
    s_add_u32 s71, s52, 49152
    buffer_load_dwordx4 v[212:215], v2, s[8:11], s71 offen offset:0
    s_waitcnt lgkmcnt(0)
    v_and_b32 v52, v60, v5
    v_and_b32 v53, v60, v6
    v_and_b32 v54, v60, v7
    v_and_b32 v55, v60, v8
    ds_bpermute_b32 v61, v4, v36 offset:96
    s_waitcnt vmcnt(42)
    v_mfma_f32_16x16x32_bf16 v[40:43], v[216:219], v[52:55], v[40:43]
    s_waitcnt vmcnt(41)
    v_mfma_f32_16x16x32_bf16 v[44:47], v[220:223], v[52:55], v[44:47]
    s_waitcnt vmcnt(40)
    v_mfma_f32_16x16x32_bf16 v[48:51], v[224:227], v[52:55], v[48:51]
    buffer_load_dwordx4 v[216:219], v2, s[8:11], s71 offen offset:128
    buffer_load_dwordx4 v[220:223], v2, s[8:11], s71 offen offset:256
    s_add_u32 s71, s52, 52224
    buffer_load_dwordx4 v[224:227], v2, s[8:11], s71 offen offset:0
    s_waitcnt lgkmcnt(0)
    v_and_b32 v56, v61, v5
    v_and_b32 v57, v61, v6
    v_and_b32 v58, v61, v7
    v_and_b32 v59, v61, v8
    ds_bpermute_b32 v60, v4, v36 offset:128
    s_waitcnt vmcnt(42)
    v_mfma_f32_16x16x32_bf16 v[40:43], v[228:231], v[56:59], v[40:43]
    s_waitcnt vmcnt(41)
    v_mfma_f32_16x16x32_bf16 v[44:47], v[232:235], v[56:59], v[44:47]
    s_waitcnt vmcnt(40)
    v_mfma_f32_16x16x32_bf16 v[48:51], v[236:239], v[56:59], v[48:51]
    buffer_load_dwordx4 v[228:231], v2, s[8:11], s71 offen offset:128
    buffer_load_dwordx4 v[232:235], v2, s[8:11], s71 offen offset:256 sc1 nt
    s_add_u32 s71, s52, 55296
    buffer_load_dwordx4 v[236:239], v2, s[8:11], s71 offen offset:0 sc1 nt
    s_waitcnt lgkmcnt(0)
    v_and_b32 v52, v60, v5
    v_and_b32 v53, v60, v6
    v_and_b32 v54, v60, v7
    v_and_b32 v55, v60, v8
    ds_bpermute_b32 v61, v4, v36 offset:160
    s_waitcnt vmcnt(38)
    ds_read_b128 v[28:31], v3 offset:0
    s_waitcnt vmcnt(37)
    ds_read_b128 v[32:35], v3 offset:1024
    v_mfma_f32_16x16x32_bf16 v[40:43], v[240:243], v[52:55], v[40:43]
    v_mfma_f32_16x16x32_bf16 v[44:47], v[244:247], v[52:55], v[44:47]
    v_mfma_f32_16x16x32_bf16 v[48:51], v[248:251], v[52:55], v[48:51]
    buffer_load_dwordx4 v[240:243], v2, s[8:11], s71 offen offset:128 sc1 nt
    buffer_load_dwordx4 v[244:247], v2, s[8:11], s71 offen offset:256 sc1 nt
    s_add_u32 s71, s52, 58368
    buffer_load_dwordx4 v[248:251], v2, s[8:11], s71 offen offset:0 sc1 nt
    s_waitcnt lgkmcnt(0)
    v_and_b32 v56, v61, v5
    v_and_b32 v57, v61, v6
    v_and_b32 v58, v61, v7
    v_and_b32 v59, v61, v8
    ds_bpermute_b32 v60, v4, v36 offset:192
    s_waitcnt vmcnt(39)
    ds_read_b128 v[12:15], v3 offset:2048
    s_waitcnt vmcnt(38)
    ds_read_b128 v[16:19], v3 offset:3072
    s_waitcnt vmcnt(37)
    ds_read_b128 v[20:23], v3 offset:4096
    v_mfma_f32_16x16x32_bf16 v[40:43], v[252:255], v[56:59], v[40:43]
    v_mfma_f32_16x16x32_bf16 v[44:47], v[28:31], v[56:59], v[44:47]
    v_mfma_f32_16x16x32_bf16 v[48:51], v[32:35], v[56:59], v[48:51]
    buffer_load_dwordx4 v[252:255], v2, s[8:11], s71 offen offset:128 sc1 nt
    s_add_u32 m0, s67, 4294967040
    s_nop 0
    buffer_load_dwordx4 v2, s[8:11], s71 offen offset:256 sc1 nt lds
    s_add_u32 s71, s52, 61440
    s_add_u32 m0, s67, 1024
    s_nop 0
    buffer_load_dwordx4 v2, s[8:11], s71 offen offset:0 sc1 nt lds
    s_waitcnt lgkmcnt(0)
    v_and_b32 v52, v60, v5
    v_and_b32 v53, v60, v6
    v_and_b32 v54, v60, v7
    v_and_b32 v55, v60, v8
    ds_bpermute_b32 v61, v4, v36 offset:224
    s_waitcnt vmcnt(39)
    ds_read_b128 v[24:27], v3 offset:5120
    s_waitcnt vmcnt(38)
    ds_read_b128 v[28:31], v3 offset:6144
    s_waitcnt vmcnt(37)
    ds_read_b128 v[32:35], v3 offset:7168
    v_mfma_f32_16x16x32_bf16 v[40:43], v[12:15], v[52:55], v[40:43]
    v_mfma_f32_16x16x32_bf16 v[44:47], v[16:19], v[52:55], v[44:47]
    v_mfma_f32_16x16x32_bf16 v[48:51], v[20:23], v[52:55], v[48:51]
    s_add_u32 m0, s67, 1920
    s_nop 0
    buffer_load_dwordx4 v2, s[8:11], s71 offen offset:128 sc1 nt lds
    s_add_u32 m0, s67, 2816
    s_nop 0
    buffer_load_dwordx4 v2, s[8:11], s71 offen offset:256 sc1 nt lds
    s_add_u32 s71, s52, 64512
    s_add_u32 m0, s67, 4096
    s_nop 0
    buffer_load_dwordx4 v2, s[8:11], s71 offen offset:0 sc1 nt lds
    s_waitcnt lgkmcnt(0)
    v_and_b32 v56, v61, v5
    v_and_b32 v57, v61, v6
    v_and_b32 v58, v61, v7
    v_and_b32 v59, v61, v8
    ds_bpermute_b32 v60, v4, v37 offset:0
    s_waitcnt vmcnt(39)
    ds_read_b128 v[12:15], v3 offset:8192
    s_waitcnt vmcnt(38)
    ds_read_b128 v[16:19], v3 offset:9216
    s_waitcnt vmcnt(37)
    ds_read_b128 v[20:23], v3 offset:10240
    v_mfma_f32_16x16x32_bf16 v[40:43], v[24:27], v[56:59], v[40:43]
    v_mfma_f32_16x16x32_bf16 v[44:47], v[28:31], v[56:59], v[44:47]
    v_mfma_f32_16x16x32_bf16 v[48:51], v[32:35], v[56:59], v[48:51]
    s_add_u32 m0, s67, 4992
    s_nop 0
    buffer_load_dwordx4 v2, s[8:11], s71 offen offset:128 sc1 nt lds
    s_add_u32 m0, s67, 5888
    s_nop 0
    buffer_load_dwordx4 v2, s[8:11], s71 offen offset:256 sc1 nt lds
    s_add_u32 s71, s52, 67584
    s_add_u32 m0, s67, 7168
    s_nop 0
    buffer_load_dwordx4 v2, s[8:11], s71 offen offset:0 sc1 nt lds
    s_waitcnt lgkmcnt(0)
    v_and_b32 v52, v60, v5
    v_and_b32 v53, v60, v6
    v_and_b32 v54, v60, v7
    v_and_b32 v55, v60, v8
    ds_bpermute_b32 v61, v4, v37 offset:32
    s_waitcnt vmcnt(39)
    ds_read_b128 v[24:27], v3 offset:11264
    s_waitcnt vmcnt(38)
    ds_read_b128 v[28:31], v3 offset:12288
    s_waitcnt vmcnt(37)
    ds_read_b128 v[32:35], v3 offset:13312
    v_mfma_f32_16x16x32_bf16 v[40:43], v[12:15], v[52:55], v[40:43]
    v_mfma_f32_16x16x32_bf16 v[44:47], v[16:19], v[52:55], v[44:47]
    v_mfma_f32_16x16x32_bf16 v[48:51], v[20:23], v[52:55], v[48:51]
    s_add_u32 m0, s67, 8064
    s_nop 0
    buffer_load_dwordx4 v2, s[8:11], s71 offen offset:128 sc1 nt lds
    s_add_u32 m0, s67, 8960
    s_nop 0
    buffer_load_dwordx4 v2, s[8:11], s71 offen offset:256 sc1 nt lds
    s_add_u32 s71, s52, 70656
    s_add_u32 m0, s67, 10240
    s_nop 0
    buffer_load_dwordx4 v2, s[8:11], s71 offen offset:0 sc1 nt lds
    s_waitcnt lgkmcnt(0)
    v_and_b32 v56, v61, v5
    v_and_b32 v57, v61, v6
    v_and_b32 v58, v61, v7
    v_and_b32 v59, v61, v8
    ds_bpermute_b32 v60, v4, v37 offset:64
    s_waitcnt vmcnt(39)
    ds_read_b128 v[12:15], v3 offset:14336
    s_waitcnt vmcnt(38)
    ds_read_b128 v[16:19], v3 offset:15360
    s_waitcnt vmcnt(37)
    ds_read_b128 v[20:23], v3 offset:16384
    v_mfma_f32_16x16x32_bf16 v[40:43], v[24:27], v[56:59], v[40:43]
    v_mfma_f32_16x16x32_bf16 v[44:47], v[28:31], v[56:59], v[44:47]
    v_mfma_f32_16x16x32_bf16 v[48:51], v[32:35], v[56:59], v[48:51]
    s_add_u32 m0, s67, 11136
    s_nop 0
    buffer_load_dwordx4 v2, s[8:11], s71 offen offset:128 sc1 nt lds
    s_add_u32 m0, s67, 12032
    s_nop 0
    buffer_load_dwordx4 v2, s[8:11], s71 offen offset:256 sc1 nt lds
    s_add_u32 s71, s52, 73728
    s_add_u32 m0, s67, 13312
    s_nop 0
    buffer_load_dwordx4 v2, s[8:11], s71 offen offset:0 sc1 nt lds
    s_waitcnt lgkmcnt(0)
    v_and_b32 v52, v60, v5
    v_and_b32 v53, v60, v6
    v_and_b32 v54, v60, v7
    v_and_b32 v55, v60, v8
    ds_bpermute_b32 v61, v4, v37 offset:96
    s_waitcnt vmcnt(39)
    ds_read_b128 v[24:27], v3 offset:17408
    s_waitcnt vmcnt(38)
    ds_read_b128 v[28:31], v3 offset:18432
    s_waitcnt vmcnt(37)
    ds_read_b128 v[32:35], v3 offset:19456
    v_mfma_f32_16x16x32_bf16 v[40:43], v[12:15], v[52:55], v[40:43]
    v_mfma_f32_16x16x32_bf16 v[44:47], v[16:19], v[52:55], v[44:47]
    v_mfma_f32_16x16x32_bf16 v[48:51], v[20:23], v[52:55], v[48:51]
    s_add_u32 m0, s67, 14208
    s_nop 0
    buffer_load_dwordx4 v2, s[8:11], s71 offen offset:128 sc1 nt lds
    s_add_u32 m0, s67, 15104
    s_nop 0
    buffer_load_dwordx4 v2, s[8:11], s71 offen offset:256 sc1 nt lds
    s_add_u32 s71, s52, 76800
    s_add_u32 m0, s67, 16384
    s_nop 0
    buffer_load_dwordx4 v2, s[8:11], s71 offen offset:0 sc1 nt lds
    s_waitcnt lgkmcnt(0)
    v_and_b32 v56, v61, v5
    v_and_b32 v57, v61, v6
    v_and_b32 v58, v61, v7
    v_and_b32 v59, v61, v8
    ds_bpermute_b32 v60, v4, v37 offset:128
    s_waitcnt vmcnt(39)
    ds_read_b128 v[12:15], v3 offset:20480
    s_waitcnt vmcnt(38)
    ds_read_b128 v[16:19], v3 offset:21504
    s_waitcnt vmcnt(37)
    ds_read_b128 v[20:23], v3 offset:22528
    v_mfma_f32_16x16x32_bf16 v[40:43], v[24:27], v[56:59], v[40:43]
    v_mfma_f32_16x16x32_bf16 v[44:47], v[28:31], v[56:59], v[44:47]
    v_mfma_f32_16x16x32_bf16 v[48:51], v[32:35], v[56:59], v[48:51]
    s_add_u32 m0, s67, 17280
    s_nop 0
    buffer_load_dwordx4 v2, s[8:11], s71 offen offset:128 sc1 nt lds
    s_add_u32 m0, s67, 18176
    s_nop 0
    buffer_load_dwordx4 v2, s[8:11], s71 offen offset:256 sc1 nt lds
    s_add_u32 s71, s52, 79872
    s_add_u32 m0, s67, 19456
    s_nop 0
    buffer_load_dwordx4 v2, s[8:11], s71 offen offset:0 sc1 nt lds
    s_waitcnt lgkmcnt(0)
    v_and_b32 v52, v60, v5
    v_and_b32 v53, v60, v6
    v_and_b32 v54, v60, v7
    v_and_b32 v55, v60, v8
    ds_bpermute_b32 v61, v4, v37 offset:160
    s_waitcnt vmcnt(39)
    ds_read_b128 v[24:27], v3 offset:23552
    s_waitcnt vmcnt(38)
    ds_read_b128 v[28:31], v3 offset:24576
    s_waitcnt vmcnt(37)
    ds_read_b128 v[32:35], v3 offset:25600
    v_mfma_f32_16x16x32_bf16 v[40:43], v[12:15], v[52:55], v[40:43]
    v_mfma_f32_16x16x32_bf16 v[44:47], v[16:19], v[52:55], v[44:47]
    v_mfma_f32_16x16x32_bf16 v[48:51], v[20:23], v[52:55], v[48:51]
    s_add_u32 m0, s67, 20352
    s_nop 0
    buffer_load_dwordx4 v2, s[8:11], s71 offen offset:128 sc1 nt lds
    s_add_u32 m0, s67, 21248
    s_nop 0
    buffer_load_dwordx4 v2, s[8:11], s71 offen offset:256 sc1 nt lds
    s_add_u32 s71, s52, 82944
    s_add_u32 m0, s67, 22528
    s_nop 0
    buffer_load_dwordx4 v2, s[8:11], s71 offen offset:0 sc1 nt lds
    s_waitcnt lgkmcnt(0)
    v_and_b32 v56, v61, v5
    v_and_b32 v57, v61, v6
    v_and_b32 v58, v61, v7
    v_and_b32 v59, v61, v8
    ds_bpermute_b32 v60, v4, v37 offset:192
    s_waitcnt vmcnt(39)
    ds_read_b128 v[12:15], v3 offset:26624
    v_mfma_f32_16x16x32_bf16 v[40:43], v[24:27], v[56:59], v[40:43]
    v_mfma_f32_16x16x32_bf16 v[44:47], v[28:31], v[56:59], v[44:47]
    v_mfma_f32_16x16x32_bf16 v[48:51], v[32:35], v[56:59], v[48:51]
    s_add_u32 m0, s67, 23424
    s_nop 0
    buffer_load_dwordx4 v2, s[8:11], s71 offen offset:128 sc1 nt lds
    s_add_u32 m0, s67, 24320
    s_nop 0
    buffer_load_dwordx4 v2, s[8:11], s71 offen offset:256 sc1 nt lds
    s_add_u32 s71, s52, 86016
    s_add_u32 m0, s67, 25600
    s_nop 0
    buffer_load_dwordx4 v2, s[8:11], s71 offen offset:0 sc1 nt lds
    s_waitcnt lgkmcnt(0)
    v_and_b32 v52, v60, v5
    v_and_b32 v53, v60, v6
    v_and_b32 v54, v60, v7
    v_and_b32 v55, v60, v8
    ds_bpermute_b32 v61, v4, v37 offset:224
    s_nop 0
    v_mfma_f32_16x16x32_bf16 v[40:43], v[12:15], v[52:55], v[40:43]
    s_waitcnt vmcnt(41)
    v_mfma_f32_16x16x32_bf16 v[44:47], v[192:195], v[52:55], v[44:47]
    s_waitcnt vmcnt(40)
    v_mfma_f32_16x16x32_bf16 v[48:51], v[196:199], v[52:55], v[48:51]
    s_add_u32 m0, s67, 26496
    s_nop 0
    buffer_load_dwordx4 v2, s[8:11], s71 offen offset:128 sc1 nt lds
    buffer_load_dwordx4 v[192:195], v2, s[8:11], s71 offen offset:256 sc1 nt
    s_add_u32 s71, s52, 89088
    buffer_load_dwordx4 v[196:199], v2, s[8:11], s71 offen offset:0 sc1 nt
    s_waitcnt lgkmcnt(0)
    v_and_b32 v56, v61, v5
    v_and_b32 v57, v61, v6
    v_and_b32 v58, v61, v7
    v_and_b32 v59, v61, v8
    ds_bpermute_b32 v60, v4, v38 offset:0
    s_waitcnt vmcnt(42)
    v_mfma_f32_16x16x32_bf16 v[40:43], v[200:203], v[56:59], v[40:43]
    s_waitcnt vmcnt(41)
    v_mfma_f32_16x16x32_bf16 v[44:47], v[204:207], v[56:59], v[44:47]
    s_waitcnt vmcnt(40)
    v_mfma_f32_16x16x32_bf16 v[48:51], v[208:211], v[56:59], v[48:51]
    buffer_load_dwordx4 v[200:203], v2, s[8:11], s71 offen offset:128 sc1 nt
    buffer_load_dwordx4 v[204:207], v2, s[8:11], s71 offen offset:256 sc1 nt
    s_add_u32 s71, s52, 92160
    buffer_load_dwordx4 v[208:211], v2, s[8:11], s71 offen offset:0 sc1 nt
    s_waitcnt lgkmcnt(0)
    v_and_b32 v52, v60, v5
    v_and_b32 v53, v60, v6
    v_and_b32 v54, v60, v7
    v_and_b32 v55, v60, v8
    ds_bpermute_b32 v61, v4, v38 offset:32
    s_waitcnt vmcnt(42)
    v_mfma_f32_16x16x32_bf16 v[40:43], v[212:215], v[52:55], v[40:43]
    s_waitcnt vmcnt(41)
    v_mfma_f32_16x16x32_bf16 v[44:47], v[216:219], v[52:55], v[44:47]
    s_waitcnt vmcnt(40)
    v_mfma_f32_16x16x32_bf16 v[48:51], v[220:223], v[52:55], v[48:51]
    buffer_load_dwordx4 v[212:215], v2, s[8:11], s71 offen offset:128 sc1 nt
    buffer_load_dwordx4 v[216:219], v2, s[8:11], s71 offen offset:256 sc1 nt
    s_add_u32 s71, s52, 95232
    buffer_load_dwordx4 v[220:223], v2, s[8:11], s71 offen offset:0 sc1 nt
    s_waitcnt lgkmcnt(0)
    v_and_b32 v56, v61, v5
    v_and_b32 v57, v61, v6
    v_and_b32 v58, v61, v7
    v_and_b32 v59, v61, v8
    ds_bpermute_b32 v60, v4, v38 offset:64
    s_waitcnt vmcnt(42)
    v_mfma_f32_16x16x32_bf16 v[40:43], v[224:227], v[56:59], v[40:43]
    s_waitcnt vmcnt(41)
    v_mfma_f32_16x16x32_bf16 v[44:47], v[228:231], v[56:59], v[44:47]
    s_waitcnt vmcnt(40)
    v_mfma_f32_16x16x32_bf16 v[48:51], v[232:235], v[56:59], v[48:51]
    buffer_load_dwordx4 v[224:227], v2, s[8:11], s71 offen offset:128 sc1 nt
    buffer_load_dwordx4 v[228:231], v2, s[8:11], s71 offen offset:256 sc1 nt
    s_waitcnt lgkmcnt(0)
    v_and_b32 v52, v60, v5
    v_and_b32 v53, v60, v6
    v_and_b32 v54, v60, v7
    v_and_b32 v55, v60, v8
    ds_bpermute_b32 v61, v4, v38 offset:96
    s_waitcnt vmcnt(36)
    ds_read_b128 v[32:35], v3 offset:0
    v_mfma_f32_16x16x32_bf16 v[40:43], v[236:239], v[52:55], v[40:43]
    v_mfma_f32_16x16x32_bf16 v[44:47], v[240:243], v[52:55], v[44:47]
    v_mfma_f32_16x16x32_bf16 v[48:51], v[244:247], v[52:55], v[48:51]
    s_waitcnt lgkmcnt(0)
    v_and_b32 v56, v61, v5
    v_and_b32 v57, v61, v6
    v_and_b32 v58, v61, v7
    v_and_b32 v59, v61, v8
    ds_bpermute_b32 v60, v4, v38 offset:128
    s_waitcnt vmcnt(35)
    ds_read_b128 v[12:15], v3 offset:1024
    s_waitcnt vmcnt(34)
    ds_read_b128 v[16:19], v3 offset:2048
    s_waitcnt vmcnt(33)
    ds_read_b128 v[20:23], v3 offset:3072
    v_mfma_f32_16x16x32_bf16 v[40:43], v[248:251], v[56:59], v[40:43]
    v_mfma_f32_16x16x32_bf16 v[44:47], v[252:255], v[56:59], v[44:47]
    v_mfma_f32_16x16x32_bf16 v[48:51], v[32:35], v[56:59], v[48:51]
    s_waitcnt lgkmcnt(0)
    v_and_b32 v52, v60, v5
    v_and_b32 v53, v60, v6
    v_and_b32 v54, v60, v7
    v_and_b32 v55, v60, v8
    ds_bpermute_b32 v61, v4, v38 offset:160
    s_waitcnt vmcnt(32)
    ds_read_b128 v[24:27], v3 offset:4096
    s_waitcnt vmcnt(31)
    ds_read_b128 v[28:31], v3 offset:5120
    s_waitcnt vmcnt(30)
    ds_read_b128 v[32:35], v3 offset:6144
    v_mfma_f32_16x16x32_bf16 v[40:43], v[12:15], v[52:55], v[40:43]
    v_mfma_f32_16x16x32_bf16 v[44:47], v[16:19], v[52:55], v[44:47]
    v_mfma_f32_16x16x32_bf16 v[48:51], v[20:23], v[52:55], v[48:51]
    s_waitcnt lgkmcnt(0)
    v_and_b32 v56, v61, v5
    v_and_b32 v57, v61, v6
    v_and_b32 v58, v61, v7
    v_and_b32 v59, v61, v8
    ds_bpermute_b32 v60, v4, v38 offset:192
    s_waitcnt vmcnt(29)
    ds_read_b128 v[12:15], v3 offset:7168
    s_waitcnt vmcnt(28)
    ds_read_b128 v[16:19], v3 offset:8192
    s_waitcnt vmcnt(27)
    ds_read_b128 v[20:23], v3 offset:9216
    v_mfma_f32_16x16x32_bf16 v[40:43], v[24:27], v[56:59], v[40:43]
    v_mfma_f32_16x16x32_bf16 v[44:47], v[28:31], v[56:59], v[44:47]
    v_mfma_f32_16x16x32_bf16 v[48:51], v[32:35], v[56:59], v[48:51]
    s_waitcnt lgkmcnt(0)
    v_and_b32 v52, v60, v5
    v_and_b32 v53, v60, v6
    v_and_b32 v54, v60, v7
    v_and_b32 v55, v60, v8
    ds_bpermute_b32 v61, v4, v38 offset:224
    s_waitcnt vmcnt(26)
    ds_read_b128 v[24:27], v3 offset:10240
    s_waitcnt vmcnt(25)
    ds_read_b128 v[28:31], v3 offset:11264
    s_waitcnt vmcnt(24)
    ds_read_b128 v[32:35], v3 offset:12288
    v_mfma_f32_16x16x32_bf16 v[40:43], v[12:15], v[52:55], v[40:43]
    v_mfma_f32_16x16x32_bf16 v[44:47], v[16:19], v[52:55], v[44:47]
    v_mfma_f32_16x16x32_bf16 v[48:51], v[20:23], v[52:55], v[48:51]
    s_waitcnt lgkmcnt(0)
    v_and_b32 v56, v61, v5
    v_and_b32 v57, v61, v6
    v_and_b32 v58, v61, v7
    v_and_b32 v59, v61, v8
    ds_bpermute_b32 v60, v4, v39 offset:0
    s_waitcnt vmcnt(23)
    ds_read_b128 v[12:15], v3 offset:13312
    s_waitcnt vmcnt(22)
    ds_read_b128 v[16:19], v3 offset:14336
    s_waitcnt vmcnt(21)
    ds_read_b128 v[20:23], v3 offset:15360
    v_mfma_f32_16x16x32_bf16 v[40:43], v[24:27], v[56:59], v[40:43]
    v_mfma_f32_16x16x32_bf16 v[44:47], v[28:31], v[56:59], v[44:47]
    v_mfma_f32_16x16x32_bf16 v[48:51], v[32:35], v[56:59], v[48:51]
    s_waitcnt lgkmcnt(0)
    v_and_b32 v52, v60, v5
    v_and_b32 v53, v60, v6
    v_and_b32 v54, v60, v7
    v_and_b32 v55, v60, v8
    ds_bpermute_b32 v61, v4, v39 offset:32
    s_waitcnt vmcnt(20)
    ds_read_b128 v[24:27], v3 offset:16384
    s_waitcnt vmcnt(19)
    ds_read_b128 v[28:31], v3 offset:17408
    s_waitcnt vmcnt(18)
    ds_read_b128 v[32:35], v3 offset:18432
    v_mfma_f32_16x16x32_bf16 v[40:43], v[12:15], v[52:55], v[40:43]
    v_mfma_f32_16x16x32_bf16 v[44:47], v[16:19], v[52:55], v[44:47]
    v_mfma_f32_16x16x32_bf16 v[48:51], v[20:23], v[52:55], v[48:51]
    s_waitcnt lgkmcnt(0)
    v_and_b32 v56, v61, v5
    v_and_b32 v57, v61, v6
    v_and_b32 v58, v61, v7
    v_and_b32 v59, v61, v8
    ds_bpermute_b32 v60, v4, v39 offset:64
    s_waitcnt vmcnt(17)
    ds_read_b128 v[12:15], v3 offset:19456
    s_waitcnt vmcnt(16)
    ds_read_b128 v[16:19], v3 offset:20480
    s_waitcnt vmcnt(15)
    ds_read_b128 v[20:23], v3 offset:21504
    v_mfma_f32_16x16x32_bf16 v[40:43], v[24:27], v[56:59], v[40:43]
    v_mfma_f32_16x16x32_bf16 v[44:47], v[28:31], v[56:59], v[44:47]
    v_mfma_f32_16x16x32_bf16 v[48:51], v[32:35], v[56:59], v[48:51]
    s_waitcnt lgkmcnt(0)
    v_and_b32 v52, v60, v5
    v_and_b32 v53, v60, v6
    v_and_b32 v54, v60, v7
    v_and_b32 v55, v60, v8
    ds_bpermute_b32 v61, v4, v39 offset:96
    s_waitcnt vmcnt(14)
    ds_read_b128 v[24:27], v3 offset:22528
    s_waitcnt vmcnt(13)
    ds_read_b128 v[28:31], v3 offset:23552
    s_waitcnt vmcnt(12)
    ds_read_b128 v[32:35], v3 offset:24576
    v_mfma_f32_16x16x32_bf16 v[40:43], v[12:15], v[52:55], v[40:43]
    v_mfma_f32_16x16x32_bf16 v[44:47], v[16:19], v[52:55], v[44:47]
    v_mfma_f32_16x16x32_bf16 v[48:51], v[20:23], v[52:55], v[48:51]
    s_waitcnt lgkmcnt(0)
    v_and_b32 v56, v61, v5
    v_and_b32 v57, v61, v6
    v_and_b32 v58, v61, v7
    v_and_b32 v59, v61, v8
    ds_bpermute_b32 v60, v4, v39 offset:128
    s_waitcnt vmcnt(11)
    ds_read_b128 v[12:15], v3 offset:25600
    s_waitcnt vmcnt(10)
    ds_read_b128 v[16:19], v3 offset:26624
    v_mfma_f32_16x16x32_bf16 v[40:43], v[24:27], v[56:59], v[40:43]
    v_mfma_f32_16x16x32_bf16 v[44:47], v[28:31], v[56:59], v[44:47]
    v_mfma_f32_16x16x32_bf16 v[48:51], v[32:35], v[56:59], v[48:51]
    s_waitcnt lgkmcnt(0)
    v_and_b32 v52, v60, v5
    v_and_b32 v53, v60, v6
    v_and_b32 v54, v60, v7
    v_and_b32 v55, v60, v8
    ds_bpermute_b32 v61, v4, v39 offset:160
    s_nop 0
    v_mfma_f32_16x16x32_bf16 v[40:43], v[12:15], v[52:55], v[40:43]
    v_mfma_f32_16x16x32_bf16 v[44:47], v[16:19], v[52:55], v[44:47]
    s_waitcnt vmcnt(9)
    v_mfma_f32_16x16x32_bf16 v[48:51], v[192:195], v[52:55], v[48:51]
    v_bfe_u32 v62, v0, 2, 2
    v_lshlrev_b32 v62, 3, v62
    v_lshrrev_b32 v63, 5, v0
    v_lshl_add_u32 v62, v63, 1, v62
    v_bfe_u32 v63, v0, 4, 1
    v_add_u32 v62, v62, v63
    v_mul_u32_u24 v62, 1280, v62
    v_and_b32 v63, 3, v0
    v_lshl_add_u32 v62, v63, 4, v62
    s_mul_i32 s53, s54, 983040
    s_mul_i32 s69, s3, 245760
    s_add_u32 s53, s53, s69
    s_lshl_b32 s69, s63, 6
    s_add_u32 s53, s53, s69
    s_lshl_b32 s70, s74, 10
    s_cmp_eq_u32 s74, 1
    s_cselect_b32 s69, 0, 11264
    s_add_u32 m0, s66, s69
    s_add_u32 s69, s53, 0
    buffer_load_dwordx4 v62, s[20:23], s69 offen lds
    s_add_u32 m0, m0, s70
    s_add_u32 s69, s53, 5120
    buffer_load_dwordx4 v62, s[20:23], s69 offen lds
    s_add_u32 m0, m0, s70
    s_add_u32 s69, s53, 40960
    buffer_load_dwordx4 v62, s[20:23], s69 offen lds
    s_add_u32 m0, m0, s70
    s_add_u32 s69, s53, 46080
    buffer_load_dwordx4 v62, s[20:23], s69 offen lds
    s_add_u32 m0, m0, s70
    s_add_u32 s69, s53, 81920
    buffer_load_dwordx4 v62, s[20:23], s69 offen lds
    s_add_u32 m0, m0, s70
    s_add_u32 s69, s53, 87040
    buffer_load_dwordx4 v62, s[20:23], s69 offen lds
    s_add_u32 m0, m0, s70
    s_add_u32 s69, s53, 122880
    buffer_load_dwordx4 v62, s[20:23], s69 offen lds
    s_add_u32 m0, m0, s70
    s_add_u32 s69, s53, 128000
    buffer_load_dwordx4 v62, s[20:23], s69 offen lds
    s_add_u32 m0, m0, s70
    s_add_u32 s69, s53, 163840
    buffer_load_dwordx4 v62, s[20:23], s69 offen lds
    s_add_u32 m0, m0, s70
    s_add_u32 s69, s53, 168960
    buffer_load_dwordx4 v62, s[20:23], s69 offen lds
    s_add_u32 m0, m0, s70
    s_add_u32 s69, s53, 204800
    buffer_load_dwordx4 v62, s[20:23], s69 offen lds
    s_add_u32 m0, m0, s70
    s_add_u32 s69, s53, 209920
    buffer_load_dwordx4 v62, s[20:23], s69 offen lds
    s_waitcnt lgkmcnt(0)
    v_and_b32 v56, v61, v5
    v_and_b32 v57, v61, v6
    v_and_b32 v58, v61, v7
    v_and_b32 v59, v61, v8
    ds_bpermute_b32 v60, v4, v39 offset:192
    s_waitcnt vmcnt(20)
    v_mfma_f32_16x16x32_bf16 v[40:43], v[196:199], v[56:59], v[40:43]
    s_waitcnt vmcnt(19)
    v_mfma_f32_16x16x32_bf16 v[44:47], v[200:203], v[56:59], v[44:47]
    s_waitcnt vmcnt(18)
    v_mfma_f32_16x16x32_bf16 v[48:51], v[204:207], v[56:59], v[48:51]
    s_waitcnt lgkmcnt(0)
    v_and_b32 v52, v60, v5
    v_and_b32 v53, v60, v6
    v_and_b32 v54, v60, v7
    v_and_b32 v55, v60, v8
    ds_bpermute_b32 v61, v4, v39 offset:224
    s_waitcnt vmcnt(17)
    v_mfma_f32_16x16x32_bf16 v[40:43], v[208:211], v[52:55], v[40:43]
    s_waitcnt vmcnt(16)
    v_mfma_f32_16x16x32_bf16 v[44:47], v[212:215], v[52:55], v[44:47]
    s_waitcnt vmcnt(15)
    v_mfma_f32_16x16x32_bf16 v[48:51], v[216:219], v[52:55], v[48:51]
    s_waitcnt lgkmcnt(0)
    v_and_b32 v56, v61, v5
    v_and_b32 v57, v61, v6
    v_and_b32 v58, v61, v7
    v_and_b32 v59, v61, v8
    s_waitcnt vmcnt(14)
    s_nop 0
    v_mfma_f32_16x16x32_bf16 v[40:43], v[220:223], v[56:59], v[40:43]
    s_waitcnt vmcnt(13)
    v_mfma_f32_16x16x32_bf16 v[44:47], v[224:227], v[56:59], v[44:47]
    s_waitcnt vmcnt(12)
    v_mfma_f32_16x16x32_bf16 v[48:51], v[228:231], v[56:59], v[48:51]
    s_nop 3
    v_permlane32_swap_b32 v40, v41
    v_permlane32_swap_b32 v42, v43
    v_permlane32_swap_b32 v44, v45
    v_permlane32_swap_b32 v46, v47
    v_permlane32_swap_b32 v48, v49
    v_permlane32_swap_b32 v50, v51
    v_add_f32_dpp v40, v41, v40 row_ror:8 row_mask:0xf bank_mask:0xf
    v_add_f32_dpp v42, v43, v42 row_ror:8 row_mask:0xf bank_mask:0xf
    v_add_f32_dpp v44, v45, v44 row_ror:8 row_mask:0xf bank_mask:0xf
    v_add_f32_dpp v46, v47, v46 row_ror:8 row_mask:0xf bank_mask:0xf
    v_add_f32_dpp v48, v49, v48 row_ror:8 row_mask:0xf bank_mask:0xf
    v_add_f32_dpp v50, v51, v50 row_ror:8 row_mask:0xf bank_mask:0xf
    s_mov_b32 exec_lo, 0x00ff00ff
    s_mov_b32 exec_hi, 0x00ff00ff
    ds_write2_b32 v9, v40, v42 offset0:0 offset1:2
    ds_write2_b32 v9, v44, v46 offset0:64 offset1:66
    ds_write2_b32 v9, v48, v50 offset0:128 offset1:130
    s_mov_b64 exec, -1
    v_min_u32 v62, 47, v0
    v_lshlrev_b32 v62, 4, v62
    v_add_u32 v62, 49152, v62
    v_mov_b32 v63, 52288
    v_lshlrev_b32 v10, 3, v0
    s_add_u32 s53, s76, s61
    v_cmp_eq_u32 vcc, 48, v0
    s_waitcnt lgkmcnt(0)
    s_barrier
    s_cmp_eq_u32 s3, 3
    s_nop 1
    s_cbranch_scc1 L_afin_13
    s_barrier
    s_branch L_ajoin_14
L_afin_13:
    ds_read_b128 v[12:15], v62 offset:0
    ds_read_b128 v[16:19], v62 offset:768
    ds_read_b128 v[20:23], v62 offset:1536
    ds_read_b128 v[24:27], v62 offset:2304
    ds_read_b128 v[28:31], v63
    s_waitcnt lgkmcnt(0)
    v_pk_add_f32 v[12:13], v[12:13], v[16:17]
    v_pk_add_f32 v[14:15], v[14:15], v[18:19]
    v_pk_add_f32 v[20:21], v[20:21], v[24:25]
    v_pk_add_f32 v[22:23], v[22:23], v[26:27]
    v_pk_add_f32 v[28:29], v[28:29], v[30:31]
    v_pk_add_f32 v[12:13], v[12:13], v[20:21]
    v_pk_add_f32 v[14:15], v[14:15], v[22:23]
    v_add_f32 v28, v28, v29
    v_cvt_pk_bf16_f32 v12, v12, v13
    v_cvt_pk_bf16_f32 v13, v14, v15
    v_cndmask_b32 v12, v12, v11, vcc
    v_cndmask_b32 v13, v13, v28, vcc
    v_min_u32 v12, -2, v12
    v_min_u32 v13, -2, v13
    s_mov_b32 exec_lo, -1
    s_mov_b32 exec_hi, 0x1ffff
    s_cmp_eq_u32 s87, 1
    s_cbranch_scc1 L_pfast_15
    buffer_store_dwordx2 v[12:13], v10, s[12:15], s53 offen sc1
    s_branch L_pjoin_16
L_pfast_15:
    buffer_store_dwordx2 v[12:13], v10, s[12:15], s53 offen
L_pjoin_16:
    s_mov_b64 exec, -1
    s_barrier
L_ajoin_14:
L_chain:
    s_cmp_eq_u32 s74, 1
    s_cbranch_scc0 L_gu_17
    v_bfe_u32 v1, v0, 1, 3
    v_lshlrev_b32 v1, 9, v1
    v_and_b32 v63, 1, v0
    v_lshl_add_u32 v1, v63, 6, v1
    v_lshrrev_b32 v62, 4, v0
    v_lshl_add_u32 v1, v62, 4, v1
    v_and_b32 v3, 1, v62
    v_lshlrev_b32 v3, 1, v3
    v_and_b32 v63, 3, v0
    v_xor_b32 v3, v3, v63
    v_lshlrev_b32 v3, 9, v3
    v_lshrrev_b32 v62, 1, v62
    v_lshl_add_u32 v3, v62, 11, v3
    s_lshl_b32 s70, s54, 2
    s_add_u32 s70, s70, s3
    s_lshl_b32 s70, s70, 12
    s_add_u32 s70, s70, 32768
    s_add_u32 s70, s70, s61
    v_mov_b32 v24, 0
    v_mov_b32 v25, 0
    s_cmp_eq_u32 s61, 0
    s_cselect_b32 s96, s36, s12
    s_cselect_b32 s97, s37, s13
    s_cselect_b32 s98, s38, s14
    s_mov_b32 s99, 0x20000
    s_cselect_b32 s69, 1280, 32
    s_cselect_b32 s53, 32, 128
    v_lshrrev_b32 v4, 5, v0
    v_mul_u32_u24 v6, s69, v4
    v_bfe_u32 v5, v0, 4, 1
    v_mul_u32_u24 v5, s53, v5
    v_add_u32 v6, v6, v5
    v_and_b32 v5, 14, v0
    v_lshl_add_u32 v6, v5, 1, v6
    s_lshl_b32 s53, s53, 1
    s_mul_i32 s53, s53, s63
    s_cmp_eq_u32 s61, 0
    s_cselect_b32 s69, 0, 204800
    s_add_u32 s53, s53, s69
    s_cmp_eq_u32 s54, 0
    s_cselect_b32 s53, s53, 0x100000
    v_add_u32 v6, s53, v6
    buffer_load_dword v27, v6, s[96:99], 0 offen sc1
    s_mov_b32 s68, 0
    buffer_load_dwordx4 v[12:15], v1, s[12:15], s70 offen offset:0 sc1
    buffer_load_dwordx4 v[16:19], v1, s[12:15], s70 offen offset:128 sc1
    buffer_load_dwordx4 v[20:23], v1, s[12:15], s70 offen offset:256 sc1
    s_mov_b32 exec_lo, 0x000f000f
    s_mov_b32 exec_hi, 0x000f000f
    buffer_load_dwordx2 v[24:25], v3, s[12:15], s70 offen offset:384 sc1
    s_mov_b64 exec, -1
    v_lshrrev_b32 v2, 4, v0
    v_lshlrev_b32 v2, 3, v2
    v_bfe_u32 v63, v0, 2, 2
    v_add_u32 v2, v2, v63
    v_mul_u32_u24 v2, 64, v2
    v_and_b32 v63, 3, v0
    v_lshl_add_u32 v2, v63, 3, v2
    v_add_u32 v2, s66, v2
    v_lshrrev_b32 v8, 5, v0
    v_lshlrev_b32 v8, 4, v8
    v_and_b32 v63, 15, v0
    v_add_u32 v8, v8, v63
    v_lshlrev_b32 v8, 3, v8
    v_bfe_u32 v63, v0, 4, 1
    v_add_u32 v8, v8, v63
    v_lshlrev_b32 v8, 2, v8
    s_lshl_b32 s53, s3, 3
    s_add_u32 s53, s53, 49152
    v_add_u32 v8, s53, v8
    s_waitcnt vmcnt(4)
    ds_read_b64_tr_b16 v[28:29], v2 offset:0
    ds_read_b64_tr_b16 v[30:31], v2 offset:256
    ds_read_b64_tr_b16 v[32:33], v2 offset:32
    ds_read_b64_tr_b16 v[34:35], v2 offset:288
    ds_read_b64_tr_b16 v[36:37], v2 offset:2048
    ds_read_b64_tr_b16 v[38:39], v2 offset:2304
    ds_read_b64_tr_b16 v[40:41], v2 offset:2080
    ds_read_b64_tr_b16 v[42:43], v2 offset:2336
    v_bfe_u32 v9, v0, 4, 1
    v_lshlrev_b32 v9, 1, v9
    v_lshrrev_b32 v63, 5, v0
    v_add_u32 v9, v9, v63
    v_lshlrev_b32 v9, 4, v9
    v_and_b32 v63, 15, v0
    v_add_u32 v9, v9, v63
    v_lshlrev_b32 v9, 5, v9
    v_add_u32 v9, 49152, v9
    v_and_b32 v10, 31, v0
    v_lshlrev_b32 v10, 1, v10
    v_lshrrev_b32 v63, 5, v0
    v_lshl_add_u32 v10, v63, 6, v10
    s_mul_i32 s71, s54, 20
    s_add_u32 s71, s71, s63
    s_lshl_b32 s71, s71, 7
    s_add_u32 s71, s71, 163840
    s_add_u32 s71, s71, s61
    v_and_b32 v63, 1, v0
    v_cmp_eq_u32 vcc, 1, v63
    v_lshlrev_b32 v26, 16, v27
    v_and_b32 v27, 0xffff0000, v27
    v_cndmask_b32 v26, v26, v27, vcc
    s_nop 1
    s_branch L_o_chk_21
L_o_poll_19:
    buffer_load_dwordx4 v[12:15], v1, s[12:15], s70 offen offset:0 sc1
    buffer_load_dwordx4 v[16:19], v1, s[12:15], s70 offen offset:128 sc1
    buffer_load_dwordx4 v[20:23], v1, s[12:15], s70 offen offset:256 sc1
    s_mov_b32 exec_lo, 0x000f000f
    s_mov_b32 exec_hi, 0x000f000f
    buffer_load_dwordx2 v[24:25], v3, s[12:15], s70 offen offset:384 sc1
    s_mov_b64 exec, -1
L_o_chk_21:
    s_waitcnt vmcnt(0)
    v_max3_u32 v63, v12, v13, v14
    v_max3_u32 v63, v15, v16, v63
    v_max3_u32 v63, v17, v18, v63
    v_max3_u32 v63, v19, v20, v63
    v_max3_u32 v63, v21, v22, v63
    v_max3_u32 v63, v23, v24, v63
    v_max_u32 v63, v25, v63
    v_cmp_eq_u32 vcc, -1, v63
    s_nop 1
    s_cbranch_vccz L_o_ok_20
    s_add_u32 s68, s68, 1
    s_cmp_lt_u32 s68, s77
    s_nop 1
    s_cbranch_scc1 L_o_poll_19
    s_mov_b32 s77, 0
L_o_ok_20:
    s_waitcnt lgkmcnt(4)
    v_mfma_f32_16x16x32_bf16 v[48:51], v[12:15], v[28:31], 0
    v_mfma_f32_16x16x32_bf16 v[52:55], v[12:15], v[32:35], 0
    ds_read_b64_tr_b16 v[28:29], v2 offset:4096
    ds_read_b64_tr_b16 v[30:31], v2 offset:4352
    ds_read_b64_tr_b16 v[32:33], v2 offset:4128
    ds_read_b64_tr_b16 v[34:35], v2 offset:4384
    v_max_f32_dpp v4, v24, v24 quad_perm:[1,0,3,2] row_mask:0xf bank_mask:0xf
    s_nop 1
    v_max_f32_dpp v4, v4, v4 quad_perm:[2,3,0,1] row_mask:0xf bank_mask:0xf
    s_waitcnt lgkmcnt(4)
    v_mfma_f32_16x16x32_bf16 v[56:59], v[12:15], v[36:39], 0
    v_mfma_f32_16x16x32_bf16 v[60:63], v[12:15], v[40:43], 0
    ds_read_b64_tr_b16 v[36:37], v2 offset:6144
    ds_read_b64_tr_b16 v[38:39], v2 offset:6400
    ds_read_b64_tr_b16 v[40:41], v2 offset:6176
    ds_read_b64_tr_b16 v[42:43], v2 offset:6432
    v_sub_f32 v4, v24, v4
    v_exp_f32 v4, v4
    s_waitcnt lgkmcnt(4)
    v_mfma_f32_16x16x32_bf16 v[48:51], v[16:19], v[28:31], v[48:51]
    v_mfma_f32_16x16x32_bf16 v[52:55], v[16:19], v[32:35], v[52:55]
    ds_read_b64_tr_b16 v[28:29], v2 offset:8192
    ds_read_b64_tr_b16 v[30:31], v2 offset:8448
    ds_read_b64_tr_b16 v[32:33], v2 offset:8224
    ds_read_b64_tr_b16 v[34:35], v2 offset:8480
    v_mul_f32 v5, v4, v25
    s_nop 1
    v_add_f32_dpp v5, v5, v5 quad_perm:[1,0,3,2] row_mask:0xf bank_mask:0xf
    s_waitcnt lgkmcnt(4)
    v_mfma_f32_16x16x32_bf16 v[56:59], v[16:19], v[36:39], v[56:59]
    v_mfma_f32_16x16x32_bf16 v[60:63], v[16:19], v[40:43], v[60:63]
    ds_read_b64_tr_b16 v[36:37], v2 offset:10240
    ds_read_b64_tr_b16 v[38:39], v2 offset:10496
    ds_read_b64_tr_b16 v[40:41], v2 offset:10272
    ds_read_b64_tr_b16 v[42:43], v2 offset:10528
    v_add_f32_dpp v5, v5, v5 quad_perm:[2,3,0,1] row_mask:0xf bank_mask:0xf
    v_rcp_f32 v5, v5
    s_waitcnt lgkmcnt(4)
    v_mfma_f32_16x16x32_bf16 v[48:51], v[20:23], v[28:31], v[48:51]
    v_mfma_f32_16x16x32_bf16 v[52:55], v[20:23], v[32:35], v[52:55]
    v_mul_f32 v4, v4, v5
    s_waitcnt lgkmcnt(0)
    v_mfma_f32_16x16x32_bf16 v[56:59], v[20:23], v[36:39], v[56:59]
    v_mfma_f32_16x16x32_bf16 v[60:63], v[20:23], v[40:43], v[60:63]
    s_nop 6
    v_add_f32 v48, v48, v57
    v_add_f32 v50, v50, v59
    v_add_f32 v52, v52, v61
    v_add_f32 v54, v54, v63
    v_mul_f32_dpp v6, v4, v48 row_newbcast:0 row_mask:0xf bank_mask:0xf
    s_nop 1
    v_fmac_f32_dpp v6, v4, v50 row_newbcast:1 row_mask:0xf bank_mask:0xf
    v_mul_f32_dpp v7, v4, v52 row_newbcast:0 row_mask:0xf bank_mask:0xf
    s_nop 1
    v_fmac_f32_dpp v7, v4, v54 row_newbcast:1 row_mask:0xf bank_mask:0xf
    ds_write_b32 v8, v6
    ds_write_b32 v8, v7 offset:1024
    s_waitcnt lgkmcnt(0)
    s_barrier
    s_cmp_eq_u32 s3, 3
    s_cbranch_scc1 L_wfin_22
    s_barrier
    s_branch L_wjoin_23
L_wfin_22:
    ds_read_b128 v[12:15], v9
    ds_read_b128 v[16:19], v9 offset:16
    s_waitcnt lgkmcnt(0)
    v_pk_add_f32 v[12:13], v[12:13], v[16:17]
    v_pk_add_f32 v[14:15], v[14:15], v[18:19]
    v_pk_add_f32 v[12:13], v[12:13], v[14:15]
    v_add_f32 v12, v12, v13
    v_add_f32 v12, v12, v26
    s_nop 1
    v_mov_b32_dpp v13, v12 quad_perm:[1,0,3,2] row_mask:0xf bank_mask:0xf
    v_cvt_pk_bf16_f32 v12, v12, v13
    v_min_u32 v12, -2, v12
    s_mov_b32 exec_lo, 0x55555555
    s_mov_b32 exec_hi, 0x55555555
    buffer_store_dword v12, v10, s[12:15], s71 offen sc1
    s_mov_b64 exec, -1
    s_barrier
L_wjoin_23:
    s_cmp_eq_u32 s75, 1
    s_cbranch_scc0 L_nodn_24
    v_lshrrev_b32 v62, 1, v0
    v_mul_u32_u24 v62, 1280, v62
    v_and_b32 v63, 1, v0
    v_lshl_add_u32 v62, v63, 4, v62
    s_mul_i32 s53, s3, 491520
    s_lshl_b32 s69, s65, 5
    s_add_u32 s53, s53, s69
    s_add_u32 m0, s66, 0
    s_add_u32 s69, s53, 0
    buffer_load_dwordx4 v62, s[32:35], s69 offen lds
    s_add_u32 m0, s66, 1024
    s_add_u32 s69, s53, 40960
    buffer_load_dwordx4 v62, s[32:35], s69 offen lds
    s_add_u32 m0, s66, 2048
    s_add_u32 s69, s53, 81920
    buffer_load_dwordx4 v62, s[32:35], s69 offen lds
    s_add_u32 m0, s66, 3072
    s_add_u32 s69, s53, 122880
    buffer_load_dwordx4 v62, s[32:35], s69 offen lds
    s_add_u32 m0, s66, 4096
    s_add_u32 s69, s53, 163840
    buffer_load_dwordx4 v62, s[32:35], s69 offen lds
    s_add_u32 m0, s66, 5120
    s_add_u32 s69, s53, 204800
    buffer_load_dwordx4 v62, s[32:35], s69 offen lds
    s_add_u32 m0, s66, 6144
    s_add_u32 s69, s53, 245760
    buffer_load_dwordx4 v62, s[32:35], s69 offen lds
    s_add_u32 m0, s66, 7168
    s_add_u32 s69, s53, 286720
    buffer_load_dwordx4 v62, s[32:35], s69 offen lds
    s_add_u32 m0, s66, 8192
    s_add_u32 s69, s53, 327680
    buffer_load_dwordx4 v62, s[32:35], s69 offen lds
    s_add_u32 m0, s66, 9216
    s_add_u32 s69, s53, 368640
    buffer_load_dwordx4 v62, s[32:35], s69 offen lds
    s_add_u32 m0, s66, 10240
    s_add_u32 s69, s53, 409600
    buffer_load_dwordx4 v62, s[32:35], s69 offen lds
    s_add_u32 m0, s66, 11264
    s_add_u32 s69, s53, 450560
    buffer_load_dwordx4 v62, s[32:35], s69 offen lds
    s_cmp_eq_u32 s3, 3
    s_cbranch_scc0 L_nores_25
    v_bfe_u32 v4, v0, 3, 1
    v_and_b32 v5, 7, v0
    v_lshlrev_b32 v1, 6, v4
    v_lshl_add_u32 v1, v5, 2, v1
    s_lshr_b32 s70, s65, 1
    s_lshl_b32 s70, s70, 7
    s_and_b32 s69, s65, 1
    s_lshl_b32 s69, s69, 5
    s_add_u32 s70, s70, s69
    s_add_u32 s70, s70, 163840
    s_add_u32 s70, s70, s61
    v_add_u32 v20, 0, v1
    v_add_u32 v21, 2560, v1
    v_add_u32 v22, 5120, v1
    v_add_u32 v23, 7680, v1
    v_add_u32 v24, 10240, v1
    v_add_u32 v25, 12800, v1
    v_add_u32 v26, 15360, v1
    v_add_u32 v27, 17920, v1
    s_mov_b32 s68, 0
    s_nop 0
L_resy_h_28:
    buffer_load_dword v12, v20, s[12:15], s70 offen sc1
    s_waitcnt vmcnt(0)
    v_cmp_eq_u32 vcc, -1, v12
    s_cbranch_vccz L_resy_hok_29
    s_add_u32 s68, s68, 1
    s_cmp_lt_u32 s68, s77
    s_nop 1
    s_cbranch_scc1 L_resy_h_28
L_resy_hok_29:
    buffer_load_dword v13, v21, s[12:15], s70 offen sc1
    buffer_load_dword v14, v22, s[12:15], s70 offen sc1
    buffer_load_dword v15, v23, s[12:15], s70 offen sc1
    buffer_load_dword v16, v24, s[12:15], s70 offen sc1
    buffer_load_dword v17, v25, s[12:15], s70 offen sc1
    buffer_load_dword v18, v26, s[12:15], s70 offen sc1
    buffer_load_dword v19, v27, s[12:15], s70 offen sc1
    s_branch L_resy_chk_30
L_resy_poll_26:
    buffer_load_dword v12, v20, s[12:15], s70 offen sc1
    buffer_load_dword v13, v21, s[12:15], s70 offen sc1
    buffer_load_dword v14, v22, s[12:15], s70 offen sc1
    buffer_load_dword v15, v23, s[12:15], s70 offen sc1
    buffer_load_dword v16, v24, s[12:15], s70 offen sc1
    buffer_load_dword v17, v25, s[12:15], s70 offen sc1
    buffer_load_dword v18, v26, s[12:15], s70 offen sc1
    buffer_load_dword v19, v27, s[12:15], s70 offen sc1
L_resy_chk_30:
    s_waitcnt vmcnt(0)
    v_max3_u32 v63, v12, v13, v14
    v_max3_u32 v63, v15, v16, v63
    v_max3_u32 v63, v17, v18, v63
    v_max_u32 v63, v19, v63
    v_cmp_eq_u32 vcc, -1, v63
    s_nop 1
    s_cbranch_vccz L_resy_ok_27
    s_add_u32 s68, s68, 1
    s_cmp_lt_u32 s68, s77
    s_nop 1
    s_cbranch_scc1 L_resy_poll_26
    s_mov_b32 s77, 0
L_resy_ok_27:
    v_mov_b32 v2, 0
    v_mov_b32 v3, 0
    v_lshlrev_b32 v62, 16, v12
    v_and_b32 v63, 0xffff0000, v12
    v_add_f32 v2, v2, v62
    v_add_f32 v3, v3, v63
    v_lshlrev_b32 v62, 16, v13
    v_and_b32 v63, 0xffff0000, v13
    v_add_f32 v2, v2, v62
    v_add_f32 v3, v3, v63
    v_lshlrev_b32 v62, 16, v14
    v_and_b32 v63, 0xffff0000, v14
    v_add_f32 v2, v2, v62
    v_add_f32 v3, v3, v63
    v_lshlrev_b32 v62, 16, v15
    v_and_b32 v63, 0xffff0000, v15
    v_add_f32 v2, v2, v62
    v_add_f32 v3, v3, v63
    v_lshlrev_b32 v62, 16, v16
    v_and_b32 v63, 0xffff0000, v16
    v_add_f32 v2, v2, v62
    v_add_f32 v3, v3, v63
    v_lshlrev_b32 v62, 16, v17
    v_and_b32 v63, 0xffff0000, v17
    v_add_f32 v2, v2, v62
    v_add_f32 v3, v3, v63
    v_lshlrev_b32 v62, 16, v18
    v_and_b32 v63, 0xffff0000, v18
    v_add_f32 v2, v2, v62
    v_add_f32 v3, v3, v63
    v_lshlrev_b32 v62, 16, v19
    v_and_b32 v63, 0xffff0000, v19
    v_add_f32 v2, v2, v62
    v_add_f32 v3, v3, v63
    v_lshlrev_b32 v1, 6, v4
    v_lshl_add_u32 v1, v5, 3, v1
    v_add_u32 v1, 50176, v1
    s_mov_b64 exec, 0xffff
    ds_write_b64 v1, v[2:3]
    s_mov_b64 exec, -1
L_nores_25:
    v_lshrrev_b32 v2, 4, v0
    v_lshlrev_b32 v2, 3, v2
    v_bfe_u32 v63, v0, 2, 2
    v_add_u32 v2, v2, v63
    v_mul_u32_u24 v2, 32, v2
    v_and_b32 v63, 3, v0
    v_lshl_add_u32 v2, v63, 3, v2
    v_add_u32 v2, s66, v2
    v_bfe_u32 v1, v0, 1, 3
    v_lshlrev_b32 v1, 8, v1
    v_and_b32 v63, 1, v0
    v_lshl_add_u32 v1, v63, 5, v1
    v_bfe_u32 v63, v0, 4, 1
    v_lshl_add_u32 v1, v63, 4, v1
    v_lshrrev_b32 v63, 5, v0
    v_lshl_add_u32 v1, v63, 7, v1
    s_mul_i32 s70, s3, 3072
    s_add_u32 s70, s70, 188416
    s_add_u32 s70, s70, s61
    v_lshrrev_b32 v3, 5, v0
    v_lshlrev_b32 v3, 4, v3
    v_and_b32 v63, 15, v0
    v_add_u32 v3, v3, v63
    v_lshlrev_b32 v3, 3, v3
    v_bfe_u32 v63, v0, 4, 1
    v_add_u32 v3, v3, v63
    v_lshlrev_b32 v3, 2, v3
    s_lshl_b32 s53, s3, 3
    s_add_u32 s53, s53, 49152
    v_add_u32 v3, s53, v3
    v_mov_b32 v16, 0
    v_mov_b32 v17, 0
    v_mov_b32 v18, 0
    v_mov_b32 v19, 0
    v_and_b32 v60, 31, v0
    v_lshlrev_b32 v61, 2, v60
    v_add_u32 v61, 50176, v61
    v_lshlrev_b32 v60, 5, v60
    v_add_u32 v60, 49152, v60
    s_waitcnt vmcnt(0)
    ds_read_b64_tr_b16 v[4:5], v2 offset:0
    ds_read_b64_tr_b16 v[6:7], v2 offset:128
    ds_read_b64_tr_b16 v[8:9], v2 offset:1024
    ds_read_b64_tr_b16 v[10:11], v2 offset:1152
    ds_read_b64_tr_b16 v[52:53], v2 offset:2048
    ds_read_b64_tr_b16 v[54:55], v2 offset:2176
    ds_read_b64_tr_b16 v[56:57], v2 offset:3072
    ds_read_b64_tr_b16 v[58:59], v2 offset:3200
    s_mov_b32 s68, 0
L_h_poll_31:
    buffer_load_dwordx4 v[12:15], v1, s[12:15], s70 offen sc1
    s_mov_b32 exec_lo, 0x00ff00ff
    s_mov_b32 exec_hi, 0x00ff00ff
    buffer_load_dwordx4 v[16:19], v1, s[12:15], s70 offen offset:2048 sc1
    s_mov_b64 exec, -1
    s_waitcnt vmcnt(0)
    v_max3_u32 v63, v12, v13, v14
    v_max3_u32 v63, v15, v16, v63
    v_max3_u32 v63, v17, v18, v63
    v_max_u32 v63, v19, v63
    v_cmp_eq_u32 vcc, -1, v63
    s_nop 1
    s_cbranch_vccz L_h_ok_32
    s_add_u32 s68, s68, 1
    s_cmp_lt_u32 s68, s77
    s_nop 1
    s_cbranch_scc1 L_h_poll_31
    s_mov_b32 s77, 0
L_h_ok_32:
    s_waitcnt lgkmcnt(6)
    v_mfma_f32_16x16x32_bf16 v[20:23], v[12:15], v[4:7], 0
    ds_read_b64_tr_b16 v[4:5], v2 offset:4096
    ds_read_b64_tr_b16 v[6:7], v2 offset:4224
    s_waitcnt lgkmcnt(6)
    v_mfma_f32_16x16x32_bf16 v[24:27], v[12:15], v[8:11], 0
    ds_read_b64_tr_b16 v[8:9], v2 offset:5120
    ds_read_b64_tr_b16 v[10:11], v2 offset:5248
    s_waitcnt lgkmcnt(6)
    v_mfma_f32_16x16x32_bf16 v[28:31], v[12:15], v[52:55], 0
    ds_read_b64_tr_b16 v[52:53], v2 offset:6144
    ds_read_b64_tr_b16 v[54:55], v2 offset:6272
    s_waitcnt lgkmcnt(6)
    v_mfma_f32_16x16x32_bf16 v[32:35], v[12:15], v[56:59], 0
    ds_read_b64_tr_b16 v[56:57], v2 offset:7168
    ds_read_b64_tr_b16 v[58:59], v2 offset:7296
    s_waitcnt lgkmcnt(6)
    v_mfma_f32_16x16x32_bf16 v[36:39], v[12:15], v[4:7], 0
    ds_read_b64_tr_b16 v[4:5], v2 offset:8192
    ds_read_b64_tr_b16 v[6:7], v2 offset:8320
    s_waitcnt lgkmcnt(6)
    v_mfma_f32_16x16x32_bf16 v[40:43], v[12:15], v[8:11], 0
    ds_read_b64_tr_b16 v[8:9], v2 offset:9216
    ds_read_b64_tr_b16 v[10:11], v2 offset:9344
    s_waitcnt lgkmcnt(6)
    v_mfma_f32_16x16x32_bf16 v[44:47], v[12:15], v[52:55], 0
    ds_read_b64_tr_b16 v[52:53], v2 offset:10240
    ds_read_b64_tr_b16 v[54:55], v2 offset:10368
    s_waitcnt lgkmcnt(6)
    v_mfma_f32_16x16x32_bf16 v[48:51], v[12:15], v[56:59], 0
    ds_read_b64_tr_b16 v[56:57], v2 offset:11264
    ds_read_b64_tr_b16 v[58:59], v2 offset:11392
    s_waitcnt lgkmcnt(6)
    v_mfma_f32_16x16x32_bf16 v[20:23], v[16:19], v[4:7], v[20:23]
    s_waitcnt lgkmcnt(4)
    v_mfma_f32_16x16x32_bf16 v[24:27], v[16:19], v[8:11], v[24:27]
    s_waitcnt lgkmcnt(2)
    v_mfma_f32_16x16x32_bf16 v[28:31], v[16:19], v[52:55], v[28:31]
    s_waitcnt lgkmcnt(0)
    v_mfma_f32_16x16x32_bf16 v[32:35], v[16:19], v[56:59], v[32:35]
    s_mov_b32 vcc_lo, 0xffff0000
    s_mov_b32 vcc_hi, 0xffff0000
    v_add_f32 v36, v36, v42
    v_add_f32 v44, v44, v50
    v_add_f32 v20, v20, v26
    s_nop 2
    v_add_f32 v28, v28, v34
    v_add_f32 v37, v37, v43
    v_add_f32 v45, v45, v51
    v_add_f32 v21, v21, v27
    v_add_f32 v29, v29, v35
    v_cndmask_b32 v20, v20, v28, vcc
    v_cndmask_b32 v36, v36, v44, vcc
    v_cndmask_b32 v21, v21, v29, vcc
    v_cndmask_b32 v37, v37, v45, vcc
    s_nop 0
    v_permlane32_swap_b32 v36, v21
    s_mov_b32 vcc_lo, 0
    s_mov_b32 vcc_hi, -1
    v_add_f32 v20, v20, v21
    v_add_f32 v37, v37, v36
    v_cndmask_b32 v20, v20, v37, vcc
    ds_write_b32 v3, v20
    s_waitcnt lgkmcnt(0)
    s_barrier
    s_cmp_eq_u32 s3, 3
    s_cbranch_scc1 L_dfin_33
    s_barrier
    s_branch L_djoin_34
L_dfin_33:
    ds_read_b128 v[12:15], v60
    ds_read_b128 v[16:19], v60 offset:16
    ds_read_b32 v20, v61
    v_lshrrev_b32 v4, 4, v0
    v_and_b32 v5, 15, v0
    s_waitcnt lgkmcnt(0)
    v_pk_add_f32 v[12:13], v[12:13], v[16:17]
    v_pk_add_f32 v[14:15], v[14:15], v[18:19]
    v_pk_add_f32 v[12:13], v[12:13], v[14:15]
    v_add_f32 v12, v12, v13
    v_add_f32 v12, v12, v20
    s_nop 1
    v_mov_b32_dpp v13, v12 quad_perm:[1,0,3,2] row_mask:0xf bank_mask:0xf
    v_cvt_pk_bf16_f32 v12, v12, v13
    s_mov_b32 exec_lo, 0x55555555
    s_mov_b32 exec_hi, 0
    s_cmp_eq_u32 s61, 0
    s_cbranch_scc0 L_dlast_35
    v_min_u32 v12, -2, v12
    v_lshlrev_b32 v1, 5, v4
    v_lshl_add_u32 v1, v5, 1, v1
    s_lshl_b32 s53, s65, 7
    s_add_u32 s53, s53, 204800
    buffer_store_dword v12, v1, s[12:15], s53 offen sc1
    s_mov_b64 exec, -1
    s_barrier
    s_branch L_djoin_34
L_dlast_35:
    v_mul_u32_u24 v1, 1280, v4
    v_lshl_add_u32 v1, v5, 1, v1
    s_lshl_b32 s53, s65, 5
    buffer_store_dword v12, v1, s[40:43], s53 offen
    s_mov_b64 exec, -1
    s_barrier
L_djoin_34:
L_nodn_24:
    s_branch L_after_b_18
L_gu_17:
    v_lshrrev_b32 v62, 1, v0
    v_mul_u32_u24 v62, 3072, v62
    v_and_b32 v63, 1, v0
    v_lshl_add_u32 v62, v63, 4, v62
    s_mul_i32 s53, s3, 491520
    s_lshl_b32 s69, s64, 5
    s_add_u32 s53, s53, s69
    s_add_u32 m0, s66, 0
    s_add_u32 s69, s53, 0
    buffer_load_dwordx4 v62, s[24:27], s69 offen lds
    s_add_u32 m0, s66, 1024
    s_add_u32 s69, s53, 98304
    buffer_load_dwordx4 v62, s[24:27], s69 offen lds
    s_add_u32 m0, s66, 2048
    s_add_u32 s69, s53, 196608
    buffer_load_dwordx4 v62, s[24:27], s69 offen lds
    s_add_u32 m0, s66, 3072
    s_add_u32 s69, s53, 294912
    buffer_load_dwordx4 v62, s[24:27], s69 offen lds
    s_add_u32 m0, s66, 4096
    s_add_u32 s69, s53, 393216
    buffer_load_dwordx4 v62, s[24:27], s69 offen lds
    s_add_u32 m0, s66, 5120
    s_add_u32 s69, s53, 0
    buffer_load_dwordx4 v62, s[28:31], s69 offen lds
    s_add_u32 m0, s66, 6144
    s_add_u32 s69, s53, 98304
    buffer_load_dwordx4 v62, s[28:31], s69 offen lds
    s_add_u32 m0, s66, 7168
    s_add_u32 s69, s53, 196608
    buffer_load_dwordx4 v62, s[28:31], s69 offen lds
    s_add_u32 m0, s66, 8192
    s_add_u32 s69, s53, 294912
    buffer_load_dwordx4 v62, s[28:31], s69 offen lds
    s_add_u32 m0, s66, 9216
    s_add_u32 s69, s53, 393216
    buffer_load_dwordx4 v62, s[28:31], s69 offen lds
L_gustg_36:
    v_mov_b32 v8, 0x3f803f80
    v_mov_b32 v9, 0x3f803f80
    v_mov_b32 v10, 0x3f803f80
    v_mov_b32 v11, 0x3f803f80
    v_lshrrev_b32 v2, 4, v0
    v_lshlrev_b32 v2, 3, v2
    v_bfe_u32 v63, v0, 2, 2
    v_add_u32 v2, v2, v63
    v_mul_u32_u24 v2, 32, v2
    v_and_b32 v63, 3, v0
    v_lshl_add_u32 v2, v63, 3, v2
    v_add_u32 v2, s66, v2
    v_bfe_u32 v1, v0, 1, 3
    v_mul_u32_u24 v1, 2560, v1
    v_and_b32 v63, 1, v0
    v_lshl_add_u32 v1, v63, 6, v1
    v_lshrrev_b32 v63, 4, v0
    v_lshl_add_u32 v1, v63, 4, v1
    s_mul_i32 s70, s3, 640
    s_add_u32 s70, s70, 163840
    s_add_u32 s70, s70, s61
    v_lshrrev_b32 v3, 5, v0
    v_lshlrev_b32 v3, 4, v3
    v_and_b32 v63, 15, v0
    v_add_u32 v3, v3, v63
    v_lshlrev_b32 v3, 3, v3
    v_bfe_u32 v63, v0, 4, 1
    v_add_u32 v3, v3, v63
    v_lshlrev_b32 v3, 2, v3
    s_lshl_b32 s53, s3, 3
    s_add_u32 s53, s53, 49152
    v_add_u32 v3, s53, v3
    v_lshrrev_b32 v4, 5, v0
    v_lshlrev_b32 v4, 3, v4
    v_bfe_u32 v63, v0, 4, 1
    v_add_u32 v4, v4, v63
    v_lshlrev_b32 v4, 2, v4
    s_lshl_b32 s53, s3, 3
    s_add_u32 s53, s53, 51200
    v_add_u32 v4, s53, v4
    s_waitcnt vmcnt(0)
    s_cmp_eq_u32 s61, 0
    s_cbranch_scc0 L_cs_have_37
    ds_read_b64_tr_b16 v[12:13], v2 offset:0
    ds_read_b64_tr_b16 v[14:15], v2 offset:128
    ds_read_b64_tr_b16 v[16:17], v2 offset:5120
    ds_read_b64_tr_b16 v[18:19], v2 offset:5248
    ds_read_b64_tr_b16 v[20:21], v2 offset:1024
    ds_read_b64_tr_b16 v[22:23], v2 offset:1152
    ds_read_b64_tr_b16 v[24:25], v2 offset:6144
    ds_read_b64_tr_b16 v[26:27], v2 offset:6272
    ds_read_b64_tr_b16 v[28:29], v2 offset:2048
    ds_read_b64_tr_b16 v[30:31], v2 offset:2176
    ds_read_b64_tr_b16 v[32:33], v2 offset:7168
    ds_read_b64_tr_b16 v[34:35], v2 offset:7296
    s_waitcnt lgkmcnt(6)
    ds_read_b64_tr_b16 v[36:37], v2 offset:3072
    ds_read_b64_tr_b16 v[38:39], v2 offset:3200
    ds_read_b64_tr_b16 v[40:41], v2 offset:8192
    ds_read_b64_tr_b16 v[42:43], v2 offset:8320
    ds_read_b64_tr_b16 v[44:45], v2 offset:4096
    ds_read_b64_tr_b16 v[46:47], v2 offset:4224
    ds_read_b64_tr_b16 v[56:57], v2 offset:9216
    ds_read_b64_tr_b16 v[58:59], v2 offset:9344
    s_waitcnt lgkmcnt(12)
    v_mfma_f32_16x16x32_bf16 v[48:51], v[8:11], v[12:15], 0
    v_mfma_f32_16x16x32_bf16 v[52:55], v[8:11], v[16:19], 0
    s_waitcnt lgkmcnt(12)
    v_mfma_f32_16x16x32_bf16 v[48:51], v[8:11], v[20:23], v[48:51]
    v_mfma_f32_16x16x32_bf16 v[52:55], v[8:11], v[24:27], v[52:55]
    s_waitcnt lgkmcnt(8)
    v_mfma_f32_16x16x32_bf16 v[48:51], v[8:11], v[28:31], v[48:51]
    v_mfma_f32_16x16x32_bf16 v[52:55], v[8:11], v[32:35], v[52:55]
    s_waitcnt lgkmcnt(4)
    v_mfma_f32_16x16x32_bf16 v[48:51], v[8:11], v[36:39], v[48:51]
    v_mfma_f32_16x16x32_bf16 v[52:55], v[8:11], v[40:43], v[52:55]
    s_waitcnt lgkmcnt(0)
    v_mfma_f32_16x16x32_bf16 v[48:51], v[8:11], v[44:47], v[48:51]
    v_mfma_f32_16x16x32_bf16 v[52:55], v[8:11], v[56:59], v[52:55]
    v_and_b32 v5, 15, v0
    v_lshlrev_b32 v5, 4, v5
    s_lshl_b32 s53, s3, 2
    s_add_u32 s53, s53, 52736
    v_add_u32 v5, s53, v5
    s_nop 1
    ds_write_b32 v5, v48
    ds_write_b32 v5, v52 offset:256
L_cs_have_37:
    ds_read_b64_tr_b16 v[32:33], v2 offset:0
    ds_read_b64_tr_b16 v[34:35], v2 offset:128
    ds_read_b64_tr_b16 v[36:37], v2 offset:5120
    ds_read_b64_tr_b16 v[38:39], v2 offset:5248
    ds_read_b64_tr_b16 v[40:41], v2 offset:1024
    ds_read_b64_tr_b16 v[42:43], v2 offset:1152
    ds_read_b64_tr_b16 v[44:45], v2 offset:6144
    ds_read_b64_tr_b16 v[46:47], v2 offset:6272
    v_bfe_u32 v5, v0, 4, 1
    v_and_b32 v63, 15, v0
    v_lshl_add_u32 v5, v5, 4, v63
    v_lshlrev_b32 v5, 5, v5
    v_lshrrev_b32 v62, 5, v0
    v_lshl_add_u32 v5, v62, 10, v5
    v_add_u32 v5, 49152, v5
    v_lshlrev_b32 v6, 4, v63
    v_lshl_add_u32 v6, v62, 8, v6
    v_add_u32 v6, 52736, v6
    v_bfe_u32 v7, v0, 4, 1
    v_lshlrev_b32 v7, 5, v7
    v_add_u32 v7, 51200, v7
    s_lshl_b32 s71, s64, 7
    s_add_u32 s71, s71, 188416
    s_add_u32 s71, s71, s61
    s_mov_b32 s68, 0
L_y_poll_38:
    buffer_load_dwordx4 v[12:15], v1, s[12:15], s70 offen offset:0 sc1
    buffer_load_dwordx4 v[16:19], v1, s[12:15], s70 offen offset:128 sc1
    buffer_load_dwordx4 v[20:23], v1, s[12:15], s70 offen offset:256 sc1
    buffer_load_dwordx4 v[24:27], v1, s[12:15], s70 offen offset:384 sc1
    buffer_load_dwordx4 v[28:31], v1, s[12:15], s70 offen offset:512 sc1
    s_waitcnt vmcnt(0)
    v_max3_u32 v63, v12, v13, v14
    v_max3_u32 v63, v15, v16, v63
    v_max3_u32 v63, v17, v18, v63
    v_max3_u32 v63, v19, v20, v63
    v_max3_u32 v63, v21, v22, v63
    v_max3_u32 v63, v23, v24, v63
    v_max3_u32 v63, v25, v26, v63
    v_max3_u32 v63, v27, v28, v63
    v_max3_u32 v63, v29, v30, v63
    v_max_u32 v63, v31, v63
    v_cmp_eq_u32 vcc, -1, v63
    s_nop 1
    s_cbranch_vccz L_y_ok_39
    s_add_u32 s68, s68, 1
    s_cmp_lt_u32 s68, s77
    s_nop 1
    s_cbranch_scc1 L_y_poll_38
    s_mov_b32 s77, 0
L_y_ok_39:
    v_mfma_f32_16x16x32_bf16 v[56:59], v[12:15], v[12:15], 0
    v_mfma_f32_16x16x32_bf16 v[60:63], v[12:15], v[8:11], 0
    v_mfma_f32_16x16x32_bf16 v[56:59], v[16:19], v[16:19], v[56:59]
    v_mfma_f32_16x16x32_bf16 v[60:63], v[16:19], v[8:11], v[60:63]
    v_mfma_f32_16x16x32_bf16 v[56:59], v[20:23], v[20:23], v[56:59]
    v_mfma_f32_16x16x32_bf16 v[60:63], v[20:23], v[8:11], v[60:63]
    v_mfma_f32_16x16x32_bf16 v[56:59], v[24:27], v[24:27], v[56:59]
    v_mfma_f32_16x16x32_bf16 v[60:63], v[24:27], v[8:11], v[60:63]
    v_mfma_f32_16x16x32_bf16 v[56:59], v[28:31], v[28:31], v[56:59]
    v_mfma_f32_16x16x32_bf16 v[60:63], v[28:31], v[8:11], v[60:63]
    s_waitcnt lgkmcnt(4)
    v_mfma_f32_16x16x32_bf16 v[48:51], v[12:15], v[32:35], 0
    v_mfma_f32_16x16x32_bf16 v[52:55], v[12:15], v[36:39], 0
    ds_read_b64_tr_b16 v[32:33], v2 offset:2048
    ds_read_b64_tr_b16 v[34:35], v2 offset:2176
    ds_read_b64_tr_b16 v[36:37], v2 offset:7168
    ds_read_b64_tr_b16 v[38:39], v2 offset:7296
    s_waitcnt lgkmcnt(4)
    v_mfma_f32_16x16x32_bf16 v[48:51], v[16:19], v[40:43], v[48:51]
    v_mfma_f32_16x16x32_bf16 v[52:55], v[16:19], v[44:47], v[52:55]
    ds_read_b64_tr_b16 v[40:41], v2 offset:3072
    ds_read_b64_tr_b16 v[42:43], v2 offset:3200
    ds_read_b64_tr_b16 v[44:45], v2 offset:8192
    ds_read_b64_tr_b16 v[46:47], v2 offset:8320
    v_add_f32 v56, v56, v58
    v_add_f32 v57, v57, v59
    v_add_f32 v60, v60, v62
    v_add_f32 v61, v61, v63
    s_waitcnt lgkmcnt(4)
    v_mfma_f32_16x16x32_bf16 v[48:51], v[20:23], v[32:35], v[48:51]
    v_mfma_f32_16x16x32_bf16 v[52:55], v[20:23], v[36:39], v[52:55]
    ds_read_b64_tr_b16 v[32:33], v2 offset:4096
    ds_read_b64_tr_b16 v[34:35], v2 offset:4224
    ds_read_b64_tr_b16 v[36:37], v2 offset:9216
    ds_read_b64_tr_b16 v[38:39], v2 offset:9344
    s_mov_b32 vcc_lo, 0xaaaaaaaa
    s_mov_b32 vcc_hi, 0xaaaaaaaa
    v_cndmask_b32 v56, v56, v57, vcc
    v_permlane32_swap_b32 v60, v61
    s_nop 0
    v_add_f32_dpp v56, v56, v56 row_ror:2 row_mask:0xf bank_mask:0xf
    v_add_f32 v60, v60, v61
    s_waitcnt lgkmcnt(4)
    v_mfma_f32_16x16x32_bf16 v[48:51], v[24:27], v[40:43], v[48:51]
    v_mfma_f32_16x16x32_bf16 v[52:55], v[24:27], v[44:47], v[52:55]
    v_add_f32_dpp v56, v56, v56 row_ror:4 row_mask:0xf bank_mask:0xf
    s_nop 1
    v_add_f32_dpp v56, v56, v56 row_ror:8 row_mask:0xf bank_mask:0xf
    s_nop 1
    v_mov_b32_dpp v57, v56 quad_perm:[1,1,1,1] row_mask:0xf bank_mask:0xf
    v_mov_b32_dpp v56, v56 quad_perm:[0,0,0,0] row_mask:0xf bank_mask:0xf
    s_waitcnt lgkmcnt(0)
    v_mfma_f32_16x16x32_bf16 v[48:51], v[28:31], v[32:35], v[48:51]
    v_mfma_f32_16x16x32_bf16 v[52:55], v[28:31], v[36:39], v[52:55]
    v_permlane32_swap_b32 v56, v57
    v_add_f32 v56, v56, v57
    ds_write_b32 v4, v60 offset:64
    ds_write_b32 v4, v56
    s_nop 2
    v_add_f32 v48, v48, v50
    v_add_f32 v49, v49, v51
    v_add_f32 v52, v52, v54
    v_add_f32 v53, v53, v55
    v_permlane32_swap_b32 v48, v49
    s_nop 0
    v_permlane32_swap_b32 v52, v53
    v_add_f32 v48, v48, v49
    v_add_f32 v52, v52, v53
    ds_write_b32 v3, v48
    ds_write_b32 v3, v52 offset:1024
    s_waitcnt lgkmcnt(0)
    s_barrier
    s_cmp_eq_u32 s3, 3
    s_cbranch_scc1 L_gfin_40
    s_barrier
    s_branch L_gjoin_41
L_gfin_40:
    ds_read_b128 v[12:15], v5
    ds_read_b128 v[16:19], v5 offset:16
    ds_read_b128 v[20:23], v7
    ds_read_b128 v[24:27], v7 offset:16
    ds_read_b128 v[28:31], v7 offset:64
    ds_read_b128 v[32:35], v7 offset:80
    ds_read_b128 v[36:39], v6
    v_bfe_u32 v1, v0, 4, 1
    v_lshlrev_b32 v1, 5, v1
    v_and_b32 v63, 15, v0
    v_lshl_add_u32 v1, v63, 1, v1
    s_waitcnt lgkmcnt(0)
    v_pk_add_f32 v[20:21], v[20:21], v[24:25]
    v_pk_add_f32 v[22:23], v[22:23], v[26:27]
    v_pk_add_f32 v[28:29], v[28:29], v[32:33]
    v_pk_add_f32 v[30:31], v[30:31], v[34:35]
    v_pk_add_f32 v[12:13], v[12:13], v[16:17]
    v_pk_add_f32 v[14:15], v[14:15], v[18:19]
    v_pk_add_f32 v[20:21], v[20:21], v[22:23]
    v_pk_add_f32 v[28:29], v[28:29], v[30:31]
    v_pk_add_f32 v[36:37], v[36:37], v[38:39]
    v_pk_add_f32 v[12:13], v[12:13], v[14:15]
    v_add_f32 v20, v20, v21
    v_add_f32 v28, v28, v29
    v_add_f32 v36, v36, v37
    v_add_f32 v12, v12, v13
    v_mul_f32 v22, 0x3acccccd, v28
    v_mul_f32 v23, 0x3acccccd, v20
    v_fma_f32 v23, -v22, v22, v23
    v_max_f32 v23, 0, v23
    v_add_f32 v23, 0x3727c5ac, v23
    v_rsq_f32 v23, v23
    v_fma_f32 v12, -v22, v36, v12
    v_mul_f32 v12, v12, v23
    v_mov_b32 v13, v12
    s_nop 1
    v_permlane32_swap_b32 v13, v14
    v_max_f32 v12, 0, v12
    v_mul_f32 v12, v12, v14
    s_nop 1
    v_mov_b32_dpp v13, v12 quad_perm:[1,0,3,2] row_mask:0xf bank_mask:0xf
    v_cvt_pk_bf16_f32 v12, v12, v13
    v_min_u32 v12, -2, v12
    s_mov_b32 exec_lo, 0x55555555
    s_mov_b32 exec_hi, 0
    buffer_store_dword v12, v1, s[12:15], s71 offen sc1
    s_mov_b64 exec, -1
    s_barrier
L_gjoin_41:
L_after_b_18:
    s_cmp_eq_u32 s61, 0
    s_cbranch_scc0 L_fin
    s_mov_b32 s61, 262144
    s_cmp_eq_u32 s72, 1
    s_cbranch_scc0 L_noq2_42
    v_lshrrev_b32 v62, 2, v0
    v_mul_u32_u24 v62, 12288, v62
    v_and_b32 v63, 3, v0
    v_lshl_add_u32 v62, v63, 4, v62
    s_mul_i32 s53, s3, 1966080
    s_mul_i32 s69, s58, 384
    s_add_u32 s53, s53, s69
    s_lshl_b32 s69, s57, 6
    s_add_u32 s53, s53, s69
    s_add_u32 m0, s66, 0
    s_nop 0
    buffer_load_dwordx4 v62, s[16:19], s53 offen sc1 nt lds
    s_add_u32 m0, s66, 1024
    s_add_u32 s53, s53, 196608
    buffer_load_dwordx4 v62, s[16:19], s53 offen sc1 nt lds
    s_add_u32 m0, s66, 2048
    s_add_u32 s53, s53, 196608
    buffer_load_dwordx4 v62, s[16:19], s53 offen sc1 nt lds
    s_add_u32 m0, s66, 3072
    s_add_u32 s53, s53, 196608
    buffer_load_dwordx4 v62, s[16:19], s53 offen sc1 nt lds
    s_add_u32 m0, s66, 4096
    s_add_u32 s53, s53, 196608
    buffer_load_dwordx4 v62, s[16:19], s53 offen sc1 nt lds
    s_add_u32 m0, s66, 5120
    s_add_u32 s53, s53, 196608
    buffer_load_dwordx4 v62, s[16:19], s53 offen sc1 nt lds
    s_add_u32 m0, s66, 6144
    s_add_u32 s53, s53, 196608
    buffer_load_dwordx4 v62, s[16:19], s53 offen sc1 nt lds
    s_add_u32 m0, s66, 7168
    s_add_u32 s53, s53, 196608
    buffer_load_dwordx4 v62, s[16:19], s53 offen sc1 nt lds
    s_add_u32 m0, s66, 8192
    s_add_u32 s53, s53, 196608
    buffer_load_dwordx4 v62, s[16:19], s53 offen sc1 nt lds
    s_add_u32 m0, s66, 9216
    s_add_u32 s53, s53, 196608
    buffer_load_dwordx4 v62, s[16:19], s53 offen sc1 nt lds
    v_bfe_u32 v63, v0, 3, 1
    v_lshrrev_b32 v62, 4, v0
    v_lshl_add_u32 v9, v63, 2, v62
    v_mul_u32_u24 v9, 384, v9
    v_and_b32 v63, 7, v0
    v_lshl_add_u32 v9, v63, 4, v9
    s_add_u32 s71, s52, 0
    s_add_u32 m0, s66, 10240
    s_nop 0
    buffer_load_dwordx4 v9, s[8:11], s71 offen offset:0 sc1 nt lds
    s_add_u32 m0, s66, 11136
    s_nop 0
    buffer_load_dwordx4 v9, s[8:11], s71 offen offset:128 sc1 nt lds
    v_mov_b32 v12, 0x3f803f80
    v_mov_b32 v13, 0x3f803f80
    v_mov_b32 v14, 0x3f803f80
    v_mov_b32 v15, 0x3f803f80
    v_mov_b32 v16, 0x3f803f80
    v_mov_b32 v17, 0x3f803f80
    v_mov_b32 v18, 0x3f803f80
    v_mov_b32 v19, 0x3f803f80
    v_mov_b32 v20, 0x3f803f80
    v_mov_b32 v21, 0x3f803f80
    v_mov_b32 v22, 0x3f803f80
    v_mov_b32 v23, 0x3f803f80
    v_mov_b32 v24, 0x3f803f80
    v_mov_b32 v25, 0x3f803f80
    v_mov_b32 v26, 0x3f803f80
    v_mov_b32 v27, 0x3f803f80
    v_mov_b32 v28, 0x3f803f80
    v_mov_b32 v29, 0x3f803f80
    v_mov_b32 v30, 0x3f803f80
    v_mov_b32 v31, 0x3f803f80
    v_bfe_u32 v10, v0, 2, 1
    v_lshlrev_b32 v10, 5, v10
    v_bfe_u32 v63, v0, 4, 1
    v_lshl_add_u32 v10, v63, 4, v10
    v_lshrrev_b32 v63, 5, v0
    v_lshl_add_u32 v10, v63, 7, v10
    s_mul_i32 s70, s3, 1280
    s_add_u32 s70, s70, 204800
    s_waitcnt vmcnt(0)
    v_lshrrev_b32 v2, 4, v0
    v_lshlrev_b32 v2, 3, v2
    v_bfe_u32 v63, v0, 2, 2
    v_add_u32 v2, v2, v63
    v_mul_u32_u24 v2, 64, v2
    v_and_b32 v63, 3, v0
    v_lshl_add_u32 v2, v63, 3, v2
    v_add_u32 v2, s66, v2
    ds_read_b64_tr_b16 v[32:33], v2 offset:0
    ds_read_b64_tr_b16 v[34:35], v2 offset:256
    ds_read_b64_tr_b16 v[36:37], v2 offset:32
    ds_read_b64_tr_b16 v[38:39], v2 offset:288
    ds_read_b64_tr_b16 v[40:41], v2 offset:2048
    ds_read_b64_tr_b16 v[42:43], v2 offset:2304
    ds_read_b64_tr_b16 v[44:45], v2 offset:2080
    ds_read_b64_tr_b16 v[46:47], v2 offset:2336
    v_lshlrev_b32 v3, 4, v0
    s_lshl_b32 s53, s3, 2
    s_add_u32 s53, s53, 49152
    v_add_u32 v3, s53, v3
    v_lshrrev_b32 v4, 5, v0
    v_bfe_u32 v5, v0, 4, 1
    v_and_b32 v63, 15, v0
    v_lshlrev_b32 v6, 4, v63
    v_lshl_add_u32 v6, v5, 10, v6
    v_add_u32 v6, 49152, v6
    v_lshl_add_u32 v5, v4, 8, v6
    v_mul_u32_u24 v7, 320, v4
    v_add_u32 v7, 51200, v7
    v_lshlrev_b32 v8, 8, v4
    v_add_u32 v8, 51328, v8
    v_and_b32 v1, 31, v0
    v_lshlrev_b32 v1, 1, v1
    v_lshl_add_u32 v1, v4, 6, v1
    s_mul_i32 s69, s58, 6
    s_add_u32 s69, s69, s57
    s_lshl_b32 s69, s69, 7
    s_add_u32 s69, s69, s61
    s_mov_b32 s68, 0
L_x_poll_44:
    s_mov_b32 exec_lo, 0x00ff00ff
    s_mov_b32 exec_hi, 0x00ff00ff
    buffer_load_dwordx4 v[12:15], v10, s[12:15], s70 offen offset:0 sc1
    buffer_load_dwordx4 v[16:19], v10, s[12:15], s70 offen offset:256 sc1
    buffer_load_dwordx4 v[20:23], v10, s[12:15], s70 offen offset:512 sc1
    buffer_load_dwordx4 v[24:27], v10, s[12:15], s70 offen offset:768 sc1
    buffer_load_dwordx4 v[28:31], v10, s[12:15], s70 offen offset:1024 sc1
    s_mov_b64 exec, -1
    s_waitcnt vmcnt(0)
    v_max3_u32 v63, v12, v13, v14
    v_max3_u32 v63, v15, v16, v63
    v_max3_u32 v63, v17, v18, v63
    v_max3_u32 v63, v19, v20, v63
    v_max3_u32 v63, v21, v22, v63
    v_max3_u32 v63, v23, v24, v63
    v_max3_u32 v63, v25, v26, v63
    v_max3_u32 v63, v27, v28, v63
    v_max3_u32 v63, v29, v30, v63
    v_max_u32 v63, v31, v63
    v_cmp_eq_u32 vcc, -1, v63
    s_nop 1
    s_cbranch_vccz L_x_ok_45
    s_add_u32 s68, s68, 1
    s_cmp_lt_u32 s68, s77
    s_nop 1
    s_cbranch_scc1 L_x_poll_44
    s_mov_b32 s77, 0
L_x_ok_45:
    s_waitcnt lgkmcnt(4)
    v_mfma_f32_16x16x32_bf16 v[56:59], v[12:15], v[12:15], 0
    v_mfma_f32_16x16x32_bf16 v[48:51], v[12:15], v[32:35], 0
    v_mfma_f32_16x16x32_bf16 v[52:55], v[12:15], v[36:39], 0
    ds_read_b64_tr_b16 v[32:33], v2 offset:4096
    ds_read_b64_tr_b16 v[34:35], v2 offset:4352
    ds_read_b64_tr_b16 v[36:37], v2 offset:4128
    ds_read_b64_tr_b16 v[38:39], v2 offset:4384
    s_waitcnt lgkmcnt(4)
    v_mfma_f32_16x16x32_bf16 v[56:59], v[16:19], v[16:19], v[56:59]
    v_mfma_f32_16x16x32_bf16 v[48:51], v[16:19], v[40:43], v[48:51]
    v_mfma_f32_16x16x32_bf16 v[52:55], v[16:19], v[44:47], v[52:55]
    ds_read_b64_tr_b16 v[40:41], v2 offset:6144
    ds_read_b64_tr_b16 v[42:43], v2 offset:6400
    ds_read_b64_tr_b16 v[44:45], v2 offset:6176
    ds_read_b64_tr_b16 v[46:47], v2 offset:6432
    s_waitcnt lgkmcnt(4)
    v_mfma_f32_16x16x32_bf16 v[56:59], v[20:23], v[20:23], v[56:59]
    v_mfma_f32_16x16x32_bf16 v[48:51], v[20:23], v[32:35], v[48:51]
    v_mfma_f32_16x16x32_bf16 v[52:55], v[20:23], v[36:39], v[52:55]
    ds_read_b64_tr_b16 v[32:33], v2 offset:8192
    ds_read_b64_tr_b16 v[34:35], v2 offset:8448
    ds_read_b64_tr_b16 v[36:37], v2 offset:8224
    ds_read_b64_tr_b16 v[38:39], v2 offset:8480
    s_waitcnt lgkmcnt(4)
    v_mfma_f32_16x16x32_bf16 v[56:59], v[24:27], v[24:27], v[56:59]
    v_mfma_f32_16x16x32_bf16 v[48:51], v[24:27], v[40:43], v[48:51]
    v_mfma_f32_16x16x32_bf16 v[52:55], v[24:27], v[44:47], v[52:55]
    s_waitcnt lgkmcnt(0)
    v_mfma_f32_16x16x32_bf16 v[56:59], v[28:31], v[28:31], v[56:59]
    v_mfma_f32_16x16x32_bf16 v[48:51], v[28:31], v[32:35], v[48:51]
    v_mfma_f32_16x16x32_bf16 v[52:55], v[28:31], v[36:39], v[52:55]
    s_nop 5
    ds_write_b32 v3, v56 offset:2048
    ds_write_b32 v3, v48
    ds_write_b32 v3, v52 offset:1024
    s_waitcnt lgkmcnt(0)
    s_barrier
    s_cmp_eq_u32 s3, 3
    s_cbranch_scc1 L_qfin_46
    s_barrier
    s_branch L_qjoin_47
L_qfin_46:
    ds_read_b128 v[20:23], v7
    ds_read_b128 v[24:27], v8
    ds_read_b128 v[12:15], v5
    ds_read_b128 v[16:19], v6 offset:512
    s_waitcnt lgkmcnt(0)
    v_pk_add_f32 v[20:21], v[20:21], v[22:23]
    v_pk_add_f32 v[24:25], v[24:25], v[26:27]
    v_pk_add_f32 v[12:13], v[12:13], v[14:15]
    v_pk_add_f32 v[16:17], v[16:17], v[18:19]
    v_add_f32 v20, v20, v21
    v_add_f32 v24, v24, v25
    v_add_f32 v12, v12, v13
    v_add_f32 v16, v16, v17
    v_mul_f32 v22, 0x3acccccd, v24
    v_mul_f32 v23, 0x3acccccd, v20
    v_fma_f32 v23, -v22, v22, v23
    v_max_f32 v23, 0, v23
    v_add_f32 v23, 0x3727c5ac, v23
    v_rsq_f32 v23, v23
    v_fma_f32 v12, -v22, v16, v12
    v_mul_f32 v12, v12, v23
    s_nop 1
    v_mov_b32_dpp v13, v12 quad_perm:[1,0,3,2] row_mask:0xf bank_mask:0xf
    v_cvt_pk_bf16_f32 v12, v12, v13
    v_min_u32 v12, -2, v12
    s_mov_b32 exec_lo, 0x55555555
    s_mov_b32 exec_hi, 0x55555555
    s_cmp_eq_u32 s87, 1
    s_cbranch_scc1 L_pfast_48
    buffer_store_dword v12, v1, s[12:15], s69 offen sc1
    s_branch L_pjoin_49
L_pfast_48:
    buffer_store_dword v12, v1, s[12:15], s69 offen
L_pjoin_49:
    s_mov_b64 exec, -1
    s_barrier
L_qjoin_47:
    s_branch L_qdone2_43
L_noq2_42:
    s_cmp_eq_u32 s3, 3
    s_cbranch_scc1 L_qdone2_43
    v_bfe_u32 v63, v0, 3, 1
    v_lshrrev_b32 v62, 4, v0
    v_lshl_add_u32 v9, v63, 2, v62
    v_mul_u32_u24 v9, 384, v9
    v_and_b32 v63, 7, v0
    v_lshl_add_u32 v9, v63, 4, v9
    s_add_u32 s71, s52, 0
    s_add_u32 m0, s66, 10240
    s_nop 0
    buffer_load_dwordx4 v9, s[8:11], s71 offen offset:0 sc1 nt lds
    s_add_u32 m0, s66, 11136
    s_nop 0
    buffer_load_dwordx4 v9, s[8:11], s71 offen offset:128 sc1 nt lds
    s_add_u32 m0, s66, 0
    s_add_u32 s53, s71, 256
    buffer_load_dwordx4 v9, s[8:11], s53 offen sc1 nt lds
    s_add_u32 s71, s52, 3072
    s_add_u32 m0, s66, 1024
    s_nop 0
    buffer_load_dwordx4 v9, s[8:11], s71 offen offset:0 sc1 nt lds
    s_add_u32 m0, s66, 1920
    s_nop 0
    buffer_load_dwordx4 v9, s[8:11], s71 offen offset:128 sc1 nt lds
    s_add_u32 m0, s66, 2816
    s_nop 0
    buffer_load_dwordx4 v9, s[8:11], s71 offen offset:256 sc1 nt lds
    s_add_u32 s71, s52, 6144
    s_add_u32 m0, s66, 4096
    s_nop 0
    buffer_load_dwordx4 v9, s[8:11], s71 offen offset:0 sc1 nt lds
    s_add_u32 m0, s66, 4992
    s_nop 0
    buffer_load_dwordx4 v9, s[8:11], s71 offen offset:128 sc1 nt lds
    s_add_u32 m0, s66, 5888
    s_nop 0
    buffer_load_dwordx4 v9, s[8:11], s71 offen offset:256 sc1 nt lds
    s_add_u32 s71, s52, 9216
    s_add_u32 m0, s66, 7168
    s_nop 0
    buffer_load_dwordx4 v9, s[8:11], s71 offen offset:0 sc1 nt lds
    s_add_u32 m0, s66, 8064
    s_nop 0
    buffer_load_dwordx4 v9, s[8:11], s71 offen offset:128 sc1 nt lds
    s_add_u32 m0, s66, 8960
    s_nop 0
    buffer_load_dwordx4 v9, s[8:11], s71 offen offset:256 sc1 nt lds
L_qdone2_43:
    s_cmp_eq_u32 s72, 1
    s_cbranch_scc1 L_q2prod_52
    s_cmp_eq_u32 s3, 3
    s_cbranch_scc1 L_q2w3_50
    v_and_b32 v1, 7, v0
    v_mul_u32_u24 v1, 384, v1
    v_bfe_u32 v63, v0, 3, 1
    v_lshl_add_u32 v1, v63, 6, v1
    v_lshrrev_b32 v62, 4, v0
    v_lshl_add_u32 v1, v62, 4, v1
    v_lshl_add_u32 v2, v63, 2, v62
    v_lshlrev_b32 v4, 2, v2
    v_mul_u32_u24 v2, 384, v2
    v_and_b32 v63, 7, v0
    v_lshl_add_u32 v2, v63, 4, v2
    v_lshlrev_b32 v3, 4, v0
    v_add_u32 v3, s67, v3
    v_and_b32 v62, 1, v0
    v_mov_b32 v9, 0xffff
    v_lshlrev_b32 v62, 4, v62
    v_lshlrev_b32 v9, v62, v9
    v_bfe_u32 v63, v0, 1, 2
    v_cmp_eq_u32 vcc, 0, v63
    s_nop 1
    v_cndmask_b32 v5, 0, v9, vcc
    v_cmp_eq_u32 vcc, 1, v63
    s_nop 1
    v_cndmask_b32 v6, 0, v9, vcc
    v_cmp_eq_u32 vcc, 2, v63
    s_nop 1
    v_cndmask_b32 v7, 0, v9, vcc
    v_cmp_eq_u32 vcc, 3, v63
    s_nop 1
    v_cndmask_b32 v8, 0, v9, vcc
    v_lshlrev_b32 v9, 4, v0
    v_add_u32 v9, 49152, v9
    s_barrier
    ds_read_b128 v[12:15], v9 offset:0
    ds_read_b128 v[16:19], v9 offset:1024
    ds_read_b128 v[20:23], v9 offset:2048
    s_waitcnt lgkmcnt(0)
    s_branch L_q2go_51
L_q2w3_50:
    v_and_b32 v10, 1, v0
    v_lshlrev_b32 v10, 7, v10
    v_lshrrev_b32 v63, 4, v0
    v_lshl_add_u32 v10, v63, 4, v10
    s_mul_i32 s70, s58, 768
    s_lshl_b32 s69, s59, 6
    s_add_u32 s70, s70, s69
    s_add_u32 s70, s70, s61
    s_mov_b32 s68, 0
    buffer_load_dwordx4 v[12:15], v10, s[12:15], s70 offen offset:0 sc1
    buffer_load_dwordx4 v[16:19], v10, s[12:15], s70 offen offset:256 sc1
    buffer_load_dwordx4 v[20:23], v10, s[12:15], s70 offen offset:512 sc1
    v_and_b32 v1, 7, v0
    v_mul_u32_u24 v1, 384, v1
    v_bfe_u32 v63, v0, 3, 1
    v_lshl_add_u32 v1, v63, 6, v1
    v_lshrrev_b32 v62, 4, v0
    v_lshl_add_u32 v1, v62, 4, v1
    v_lshl_add_u32 v2, v63, 2, v62
    v_lshlrev_b32 v4, 2, v2
    v_mul_u32_u24 v2, 384, v2
    v_and_b32 v63, 7, v0
    v_lshl_add_u32 v2, v63, 4, v2
    v_lshlrev_b32 v3, 4, v0
    v_add_u32 v3, s67, v3
    v_and_b32 v62, 1, v0
    v_mov_b32 v9, 0xffff
    v_lshlrev_b32 v62, 4, v62
    v_lshlrev_b32 v9, v62, v9
    v_bfe_u32 v63, v0, 1, 2
    v_cmp_eq_u32 vcc, 0, v63
    s_nop 1
    v_cndmask_b32 v5, 0, v9, vcc
    v_cmp_eq_u32 vcc, 1, v63
    s_nop 1
    v_cndmask_b32 v6, 0, v9, vcc
    v_cmp_eq_u32 vcc, 2, v63
    s_nop 1
    v_cndmask_b32 v7, 0, v9, vcc
    v_cmp_eq_u32 vcc, 3, v63
    s_nop 1
    v_cndmask_b32 v8, 0, v9, vcc
    v_lshlrev_b32 v9, 4, v0
    v_add_u32 v9, 49152, v9
    s_nop 1
    s_branch L_q2_chk_55
L_q2_poll_53:
    buffer_load_dwordx4 v[12:15], v10, s[12:15], s70 offen offset:0 sc1
    buffer_load_dwordx4 v[16:19], v10, s[12:15], s70 offen offset:256 sc1
    buffer_load_dwordx4 v[20:23], v10, s[12:15], s70 offen offset:512 sc1
L_q2_chk_55:
    s_waitcnt vmcnt(0)
    v_max3_u32 v63, v12, v13, v14
    v_max3_u32 v63, v15, v16, v63
    v_max3_u32 v63, v17, v18, v63
    v_max3_u32 v63, v19, v20, v63
    v_max3_u32 v63, v21, v22, v63
    v_max_u32 v63, v23, v63
    v_cmp_eq_u32 vcc, -1, v63
    s_nop 1
    s_cbranch_vccz L_q2_ok_54
    s_add_u32 s68, s68, 1
    s_cmp_lt_u32 s68, s77
    s_nop 1
    s_cbranch_scc1 L_q2_poll_53
    s_mov_b32 s77, 0
L_q2_ok_54:
    ds_write_b128 v9, v[12:15] offset:0
    ds_write_b128 v9, v[16:19] offset:1024
    ds_write_b128 v9, v[20:23] offset:2048
    s_waitcnt lgkmcnt(0)
    s_barrier
    s_add_u32 s71, s52, 0
    s_add_u32 m0, s66, 10240
    s_nop 0
    buffer_load_dwordx4 v2, s[8:11], s71 offen offset:0 sc1 nt lds
    s_add_u32 m0, s66, 11136
    s_nop 0
    buffer_load_dwordx4 v2, s[8:11], s71 offen offset:128 sc1 nt lds
    s_add_u32 m0, s66, 0
    s_add_u32 s53, s71, 256
    buffer_load_dwordx4 v2, s[8:11], s53 offen sc1 nt lds
    s_add_u32 s71, s52, 3072
    s_add_u32 m0, s66, 1024
    s_nop 0
    buffer_load_dwordx4 v2, s[8:11], s71 offen offset:0 sc1 nt lds
    s_add_u32 m0, s66, 1920
    s_nop 0
    buffer_load_dwordx4 v2, s[8:11], s71 offen offset:128 sc1 nt lds
    s_add_u32 m0, s66, 2816
    s_nop 0
    buffer_load_dwordx4 v2, s[8:11], s71 offen offset:256 sc1 nt lds
    s_add_u32 s71, s52, 6144
    s_add_u32 m0, s66, 4096
    s_nop 0
    buffer_load_dwordx4 v2, s[8:11], s71 offen offset:0 sc1 nt lds
    s_add_u32 m0, s66, 4992
    s_nop 0
    buffer_load_dwordx4 v2, s[8:11], s71 offen offset:128 sc1 nt lds
    s_add_u32 m0, s66, 5888
    s_nop 0
    buffer_load_dwordx4 v2, s[8:11], s71 offen offset:256 sc1 nt lds
    s_add_u32 s71, s52, 9216
    s_add_u32 m0, s66, 7168
    s_nop 0
    buffer_load_dwordx4 v2, s[8:11], s71 offen offset:0 sc1 nt lds
    s_add_u32 m0, s66, 8064
    s_nop 0
    buffer_load_dwordx4 v2, s[8:11], s71 offen offset:128 sc1 nt lds
    s_add_u32 m0, s66, 8960
    s_nop 0
    buffer_load_dwordx4 v2, s[8:11], s71 offen offset:256 sc1 nt lds
    s_branch L_q2go_51
L_q2prod_52:
    v_and_b32 v10, 1, v0
    v_lshlrev_b32 v10, 7, v10
    v_lshrrev_b32 v63, 4, v0
    v_lshl_add_u32 v10, v63, 4, v10
    s_mul_i32 s70, s58, 768
    s_lshl_b32 s69, s59, 6
    s_add_u32 s70, s70, s69
    s_add_u32 s70, s70, s61
    s_mov_b32 s68, 0
    buffer_load_dwordx4 v[12:15], v10, s[12:15], s70 offen offset:0 sc1
    buffer_load_dwordx4 v[16:19], v10, s[12:15], s70 offen offset:256 sc1
    buffer_load_dwordx4 v[20:23], v10, s[12:15], s70 offen offset:512 sc1
    v_and_b32 v1, 7, v0
    v_mul_u32_u24 v1, 384, v1
    v_bfe_u32 v63, v0, 3, 1
    v_lshl_add_u32 v1, v63, 6, v1
    v_lshrrev_b32 v62, 4, v0
    v_lshl_add_u32 v1, v62, 4, v1
    v_lshl_add_u32 v2, v63, 2, v62
    v_lshlrev_b32 v4, 2, v2
    v_mul_u32_u24 v2, 384, v2
    v_and_b32 v63, 7, v0
    v_lshl_add_u32 v2, v63, 4, v2
    v_lshlrev_b32 v3, 4, v0
    v_add_u32 v3, s67, v3
    v_and_b32 v62, 1, v0
    v_mov_b32 v9, 0xffff
    v_lshlrev_b32 v62, 4, v62
    v_lshlrev_b32 v9, v62, v9
    v_bfe_u32 v63, v0, 1, 2
    v_cmp_eq_u32 vcc, 0, v63
    s_nop 1
    v_cndmask_b32 v5, 0, v9, vcc
    v_cmp_eq_u32 vcc, 1, v63
    s_nop 1
    v_cndmask_b32 v6, 0, v9, vcc
    v_cmp_eq_u32 vcc, 2, v63
    s_nop 1
    v_cndmask_b32 v7, 0, v9, vcc
    v_cmp_eq_u32 vcc, 3, v63
    s_nop 1
    v_cndmask_b32 v8, 0, v9, vcc
    v_lshlrev_b32 v9, 4, v0
    v_add_u32 v9, 49152, v9
    s_nop 1
    s_branch L_q2p_chk_58
L_q2p_poll_56:
    buffer_load_dwordx4 v[12:15], v10, s[12:15], s70 offen offset:0 sc1
    buffer_load_dwordx4 v[16:19], v10, s[12:15], s70 offen offset:256 sc1
    buffer_load_dwordx4 v[20:23], v10, s[12:15], s70 offen offset:512 sc1
L_q2p_chk_58:
    s_waitcnt vmcnt(0)
    v_max3_u32 v63, v12, v13, v14
    v_max3_u32 v63, v15, v16, v63
    v_max3_u32 v63, v17, v18, v63
    v_max3_u32 v63, v19, v20, v63
    v_max3_u32 v63, v21, v22, v63
    v_max_u32 v63, v23, v63
    v_cmp_eq_u32 vcc, -1, v63
    s_nop 1
    s_cbranch_vccz L_q2p_ok_57
    s_add_u32 s68, s68, 1
    s_cmp_lt_u32 s68, s77
    s_nop 1
    s_cbranch_scc1 L_q2p_poll_56
    s_mov_b32 s77, 0
L_q2p_ok_57:
    s_add_u32 s71, s52, 0
    s_add_u32 m0, s66, 0
    s_add_u32 s53, s71, 256
    buffer_load_dwordx4 v2, s[8:11], s53 offen sc1 nt lds
    s_add_u32 s71, s52, 3072
    s_add_u32 m0, s66, 1024
    s_nop 0
    buffer_load_dwordx4 v2, s[8:11], s71 offen offset:0 sc1 nt lds
    s_add_u32 m0, s66, 1920
    s_nop 0
    buffer_load_dwordx4 v2, s[8:11], s71 offen offset:128 sc1 nt lds
    s_add_u32 m0, s66, 2816
    s_nop 0
    buffer_load_dwordx4 v2, s[8:11], s71 offen offset:256 sc1 nt lds
    s_add_u32 s71, s52, 6144
    s_add_u32 m0, s66, 4096
    s_nop 0
    buffer_load_dwordx4 v2, s[8:11], s71 offen offset:0 sc1 nt lds
    s_add_u32 m0, s66, 4992
    s_nop 0
    buffer_load_dwordx4 v2, s[8:11], s71 offen offset:128 sc1 nt lds
    s_add_u32 m0, s66, 5888
    s_nop 0
    buffer_load_dwordx4 v2, s[8:11], s71 offen offset:256 sc1 nt lds
    s_add_u32 s71, s52, 9216
    s_add_u32 m0, s66, 7168
    s_nop 0
    buffer_load_dwordx4 v2, s[8:11], s71 offen offset:0 sc1 nt lds
    s_add_u32 m0, s66, 8064
    s_nop 0
    buffer_load_dwordx4 v2, s[8:11], s71 offen offset:128 sc1 nt lds
    s_add_u32 m0, s66, 8960
    s_nop 0
    buffer_load_dwordx4 v2, s[8:11], s71 offen offset:256 sc1 nt lds
L_q2go_51:
    v_lshlrev_b32 v10, 4, v0
    v_add_u32 v10, s66, v10
    v_mfma_f32_16x16x32_bf16 v[24:27], v[12:15], a[0:3], 0
    v_mfma_f32_16x16x32_bf16 v[24:27], v[16:19], a[4:7], v[24:27]
    v_mfma_f32_16x16x32_bf16 v[24:27], v[20:23], a[8:11], v[24:27]
    s_add_u32 s71, s52, 12288
    buffer_load_dwordx4 a[0:3], v2, s[8:11], s71 offen offset:0 sc1 nt
    buffer_load_dwordx4 a[4:7], v2, s[8:11], s71 offen offset:128 sc1 nt
    buffer_load_dwordx4 a[8:11], v2, s[8:11], s71 offen offset:256 sc1 nt
    v_mfma_f32_16x16x32_bf16 v[28:31], v[12:15], a[12:15], 0
    v_mfma_f32_16x16x32_bf16 v[28:31], v[16:19], a[16:19], v[28:31]
    v_mfma_f32_16x16x32_bf16 v[28:31], v[20:23], a[20:23], v[28:31]
    s_add_u32 s71, s52, 33792
    buffer_load_dwordx4 a[12:15], v2, s[8:11], s71 offen offset:0 sc1 nt
    buffer_load_dwordx4 a[16:19], v2, s[8:11], s71 offen offset:128 sc1 nt
    buffer_load_dwordx4 a[20:23], v2, s[8:11], s71 offen offset:256 sc1 nt
    v_mfma_f32_16x16x32_bf16 v[52:55], v[12:15], a[24:27], 0
    v_mfma_f32_16x16x32_bf16 v[52:55], v[16:19], a[28:31], v[52:55]
    v_mfma_f32_16x16x32_bf16 v[52:55], v[20:23], a[32:35], v[52:55]
    s_add_u32 s71, s52, 15360
    buffer_load_dwordx4 a[24:27], v2, s[8:11], s71 offen offset:0 sc1 nt
    buffer_load_dwordx4 a[28:31], v2, s[8:11], s71 offen offset:128 sc1 nt
    buffer_load_dwordx4 a[32:35], v2, s[8:11], s71 offen offset:256 sc1 nt
    v_add_f32_dpp v32, v25, v24 row_ror:8 row_mask:0x1 bank_mask:0x3
    v_mfma_f32_16x16x32_bf16 v[24:27], v[12:15], a[36:39], 0
    v_mfma_f32_16x16x32_bf16 v[24:27], v[16:19], a[40:43], v[24:27]
    v_mfma_f32_16x16x32_bf16 v[24:27], v[20:23], a[44:47], v[24:27]
    v_add_f32_dpp v32, v28, v29 row_ror:8 row_mask:0x1 bank_mask:0xc
    v_mfma_f32_16x16x32_bf16 v[28:31], v[12:15], a[48:51], 0
    v_mfma_f32_16x16x32_bf16 v[28:31], v[16:19], a[52:55], v[28:31]
    v_mfma_f32_16x16x32_bf16 v[28:31], v[20:23], a[56:59], v[28:31]
    v_add_f32_dpp v32, v53, v52 row_ror:8 row_mask:0x2 bank_mask:0x3
    v_mfma_f32_16x16x32_bf16 v[52:55], v[12:15], a[60:63], 0
    v_mfma_f32_16x16x32_bf16 v[52:55], v[16:19], a[64:67], v[52:55]
    v_mfma_f32_16x16x32_bf16 v[52:55], v[20:23], a[68:71], v[52:55]
    v_add_f32_dpp v32, v24, v25 row_ror:8 row_mask:0x2 bank_mask:0xc
    v_mfma_f32_16x16x32_bf16 v[24:27], v[12:15], a[72:75], 0
    v_mfma_f32_16x16x32_bf16 v[24:27], v[16:19], a[76:79], v[24:27]
    v_mfma_f32_16x16x32_bf16 v[24:27], v[20:23], a[80:83], v[24:27]
    v_add_f32_dpp v32, v29, v28 row_ror:8 row_mask:0x4 bank_mask:0x3
    v_mfma_f32_16x16x32_bf16 v[28:31], v[12:15], a[84:87], 0
    v_mfma_f32_16x16x32_bf16 v[28:31], v[16:19], a[88:91], v[28:31]
    v_mfma_f32_16x16x32_bf16 v[28:31], v[20:23], a[92:95], v[28:31]
    v_add_f32_dpp v32, v52, v53 row_ror:8 row_mask:0x4 bank_mask:0xc
    v_mfma_f32_16x16x32_bf16 v[52:55], v[12:15], a[96:99], 0
    v_mfma_f32_16x16x32_bf16 v[52:55], v[16:19], a[100:103], v[52:55]
    v_mfma_f32_16x16x32_bf16 v[52:55], v[20:23], a[104:107], v[52:55]
    v_add_f32_dpp v32, v25, v24 row_ror:8 row_mask:0x8 bank_mask:0x3
    v_mfma_f32_16x16x32_bf16 v[24:27], v[12:15], a[108:111], 0
    v_mfma_f32_16x16x32_bf16 v[24:27], v[16:19], a[112:115], v[24:27]
    v_mfma_f32_16x16x32_bf16 v[24:27], v[20:23], a[116:119], v[24:27]
    v_add_f32_dpp v32, v28, v29 row_ror:8 row_mask:0x8 bank_mask:0xc
    v_mfma_f32_16x16x32_bf16 v[28:31], v[12:15], a[120:123], 0
    v_mfma_f32_16x16x32_bf16 v[28:31], v[16:19], a[124:127], v[28:31]
    v_mfma_f32_16x16x32_bf16 v[28:31], v[20:23], a[128:131], v[28:31]
    v_add_f32_dpp v33, v53, v52 row_ror:8 row_mask:0x1 bank_mask:0x3
    v_mfma_f32_16x16x32_bf16 v[52:55], v[12:15], a[132:135], 0
    v_mfma_f32_16x16x32_bf16 v[52:55], v[16:19], a[136:139], v[52:55]
    v_mfma_f32_16x16x32_bf16 v[52:55], v[20:23], a[140:143], v[52:55]
    v_add_f32_dpp v33, v24, v25 row_ror:8 row_mask:0x1 bank_mask:0xc
    v_mfma_f32_16x16x32_bf16 v[24:27], v[12:15], a[144:147], 0
    v_mfma_f32_16x16x32_bf16 v[24:27], v[16:19], a[148:151], v[24:27]
    v_mfma_f32_16x16x32_bf16 v[24:27], v[20:23], a[152:155], v[24:27]
    v_add_f32_dpp v33, v29, v28 row_ror:8 row_mask:0x2 bank_mask:0x3
    v_mfma_f32_16x16x32_bf16 v[28:31], v[12:15], a[156:159], 0
    v_mfma_f32_16x16x32_bf16 v[28:31], v[16:19], a[160:163], v[28:31]
    v_mfma_f32_16x16x32_bf16 v[28:31], v[20:23], a[164:167], v[28:31]
    v_add_f32_dpp v33, v52, v53 row_ror:8 row_mask:0x2 bank_mask:0xc
    v_mfma_f32_16x16x32_bf16 v[52:55], v[12:15], a[168:171], 0
    v_mfma_f32_16x16x32_bf16 v[52:55], v[16:19], a[172:175], v[52:55]
    v_mfma_f32_16x16x32_bf16 v[52:55], v[20:23], a[176:179], v[52:55]
    v_add_f32_dpp v33, v25, v24 row_ror:8 row_mask:0x4 bank_mask:0x3
    v_mfma_f32_16x16x32_bf16 v[24:27], v[12:15], a[180:183], 0
    v_mfma_f32_16x16x32_bf16 v[24:27], v[16:19], a[184:187], v[24:27]
    v_mfma_f32_16x16x32_bf16 v[24:27], v[20:23], a[188:191], v[24:27]
    v_add_f32_dpp v33, v28, v29 row_ror:8 row_mask:0x4 bank_mask:0xc
    v_mfma_f32_16x16x32_bf16 v[28:31], v[12:15], a[192:195], 0
    v_mfma_f32_16x16x32_bf16 v[28:31], v[16:19], a[196:199], v[28:31]
    v_mfma_f32_16x16x32_bf16 v[28:31], v[20:23], a[200:203], v[28:31]
    v_add_f32_dpp v33, v53, v52 row_ror:8 row_mask:0x8 bank_mask:0x3
    v_mfma_f32_16x16x32_bf16 v[52:55], v[12:15], a[204:207], 0
    v_mfma_f32_16x16x32_bf16 v[52:55], v[16:19], a[208:211], v[52:55]
    v_mfma_f32_16x16x32_bf16 v[52:55], v[20:23], a[212:215], v[52:55]
    v_add_f32_dpp v33, v24, v25 row_ror:8 row_mask:0x8 bank_mask:0xc
    v_mfma_f32_16x16x32_bf16 v[24:27], v[12:15], a[216:219], 0
    v_mfma_f32_16x16x32_bf16 v[24:27], v[16:19], a[220:223], v[24:27]
    v_mfma_f32_16x16x32_bf16 v[24:27], v[20:23], a[224:227], v[24:27]
    v_add_f32_dpp v34, v29, v28 row_ror:8 row_mask:0x1 bank_mask:0x3
    v_mfma_f32_16x16x32_bf16 v[28:31], v[12:15], a[228:231], 0
    v_mfma_f32_16x16x32_bf16 v[28:31], v[16:19], a[232:235], v[28:31]
    v_mfma_f32_16x16x32_bf16 v[28:31], v[20:23], a[236:239], v[28:31]
    v_add_f32_dpp v34, v52, v53 row_ror:8 row_mask:0x1 bank_mask:0xc
    v_mfma_f32_16x16x32_bf16 v[52:55], v[12:15], a[240:243], 0
    v_mfma_f32_16x16x32_bf16 v[52:55], v[16:19], a[244:247], v[52:55]
    v_mfma_f32_16x16x32_bf16 v[52:55], v[20:23], a[248:251], v[52:55]
    v_add_f32_dpp v34, v25, v24 row_ror:8 row_mask:0x2 bank_mask:0x3
    v_mfma_f32_16x16x32_bf16 v[24:27], v[12:15], a[252:255], 0
    v_mfma_f32_16x16x32_bf16 v[24:27], v[16:19], v[64:67], v[24:27]
    v_mfma_f32_16x16x32_bf16 v[24:27], v[20:23], v[68:71], v[24:27]
    v_add_f32_dpp v34, v28, v29 row_ror:8 row_mask:0x2 bank_mask:0xc
    v_mfma_f32_16x16x32_bf16 v[28:31], v[12:15], v[72:75], 0
    v_mfma_f32_16x16x32_bf16 v[28:31], v[16:19], v[76:79], v[28:31]
    v_mfma_f32_16x16x32_bf16 v[28:31], v[20:23], v[80:83], v[28:31]
    v_add_f32_dpp v34, v53, v52 row_ror:8 row_mask:0x4 bank_mask:0x3
    v_mfma_f32_16x16x32_bf16 v[52:55], v[12:15], v[84:87], 0
    v_mfma_f32_16x16x32_bf16 v[52:55], v[16:19], v[88:91], v[52:55]
    v_mfma_f32_16x16x32_bf16 v[52:55], v[20:23], v[92:95], v[52:55]
    v_add_f32_dpp v34, v24, v25 row_ror:8 row_mask:0x4 bank_mask:0xc
    v_mfma_f32_16x16x32_bf16 v[24:27], v[12:15], v[96:99], 0
    v_mfma_f32_16x16x32_bf16 v[24:27], v[16:19], v[100:103], v[24:27]
    v_mfma_f32_16x16x32_bf16 v[24:27], v[20:23], v[104:107], v[24:27]
    v_add_f32_dpp v34, v29, v28 row_ror:8 row_mask:0x8 bank_mask:0x3
    v_mfma_f32_16x16x32_bf16 v[28:31], v[12:15], v[108:111], 0
    v_mfma_f32_16x16x32_bf16 v[28:31], v[16:19], v[112:115], v[28:31]
    v_mfma_f32_16x16x32_bf16 v[28:31], v[20:23], v[116:119], v[28:31]
    v_add_f32_dpp v34, v52, v53 row_ror:8 row_mask:0x8 bank_mask:0xc
    v_mfma_f32_16x16x32_bf16 v[52:55], v[12:15], v[120:123], 0
    v_mfma_f32_16x16x32_bf16 v[52:55], v[16:19], v[124:127], v[52:55]
    v_mfma_f32_16x16x32_bf16 v[52:55], v[20:23], v[128:131], v[52:55]
    v_add_f32_dpp v35, v25, v24 row_ror:8 row_mask:0x1 bank_mask:0x3
    v_mfma_f32_16x16x32_bf16 v[24:27], v[12:15], v[132:135], 0
    v_mfma_f32_16x16x32_bf16 v[24:27], v[16:19], v[136:139], v[24:27]
    v_mfma_f32_16x16x32_bf16 v[24:27], v[20:23], v[140:143], v[24:27]
    v_add_f32_dpp v35, v28, v29 row_ror:8 row_mask:0x1 bank_mask:0xc
    v_mfma_f32_16x16x32_bf16 v[28:31], v[12:15], v[144:147], 0
    v_mfma_f32_16x16x32_bf16 v[28:31], v[16:19], v[148:151], v[28:31]
    v_mfma_f32_16x16x32_bf16 v[28:31], v[20:23], v[152:155], v[28:31]
    v_add_f32_dpp v35, v53, v52 row_ror:8 row_mask:0x2 bank_mask:0x3
    v_mfma_f32_16x16x32_bf16 v[52:55], v[12:15], v[156:159], 0
    v_mfma_f32_16x16x32_bf16 v[52:55], v[16:19], v[160:163], v[52:55]
    v_mfma_f32_16x16x32_bf16 v[52:55], v[20:23], v[164:167], v[52:55]
    v_add_f32_dpp v35, v24, v25 row_ror:8 row_mask:0x2 bank_mask:0xc
    v_mfma_f32_16x16x32_bf16 v[24:27], v[12:15], v[168:171], 0
    v_mfma_f32_16x16x32_bf16 v[24:27], v[16:19], v[172:175], v[24:27]
    v_mfma_f32_16x16x32_bf16 v[24:27], v[20:23], v[176:179], v[24:27]
    v_add_f32_dpp v35, v29, v28 row_ror:8 row_mask:0x4 bank_mask:0x3
    v_mfma_f32_16x16x32_bf16 v[28:31], v[12:15], v[180:183], 0
    v_mfma_f32_16x16x32_bf16 v[28:31], v[16:19], v[184:187], v[28:31]
    v_mfma_f32_16x16x32_bf16 v[28:31], v[20:23], v[188:191], v[28:31]
    v_add_f32_dpp v35, v52, v53 row_ror:8 row_mask:0x4 bank_mask:0xc
    s_nop 2
    v_add_f32_dpp v35, v25, v24 row_ror:8 row_mask:0x8 bank_mask:0x3
    s_nop 2
    v_add_f32_dpp v35, v28, v29 row_ror:8 row_mask:0x8 bank_mask:0xc
    v_max3_f32 v62, v32, v33, v34
    v_max_f32 v62, v62, v35
    s_nop 1
    v_max_f32_dpp v62, v62, v62 row_ror:8 row_mask:0xf bank_mask:0xf
    s_nop 1
    v_max_f32_dpp v62, v62, v62 row_ror:4 row_mask:0xf bank_mask:0xf
    s_nop 1
    v_max_f32_dpp v62, v62, v62 row_ror:2 row_mask:0xf bank_mask:0xf
    s_nop 1
    v_max_f32_dpp v62, v62, v62 row_ror:1 row_mask:0xf bank_mask:0xf
    v_mov_b32 v63, v62
    s_nop 1
    v_permlane16_swap_b32 v62, v63
    v_max_f32 v62, v62, v63
    v_mov_b32 v63, v62
    s_nop 1
    v_permlane32_swap_b32 v62, v63
    v_max_f32 v62, v62, v63
    s_lshl_b32 s53, s3, 2
    s_add_u32 s53, s53, 52224
    v_mov_b32 v9, s53
    ds_write_b32 v9, v62
    v_mov_b32 v63, 52224
    s_waitcnt lgkmcnt(0)
    s_barrier
    ds_read_b128 v[12:15], v63
    s_mov_b32 s53, 0x3dd53b95
    s_waitcnt lgkmcnt(0)
    v_max3_f32 v62, v12, v13, v14
    v_max_f32 v62, v62, v15
    v_mul_f32 v11, s53, v62
    v_fma_f32 v32, v32, s53, -v11
    v_fma_f32 v33, v33, s53, -v11
    v_fma_f32 v34, v34, s53, -v11
    v_fma_f32 v35, v35, s53, -v11
    v_exp_f32 v32, v32
    v_exp_f32 v33, v33
    v_exp_f32 v34, v34
    v_exp_f32 v35, v35
    v_cvt_pk_bf16_f32 v36, v32, v32
    v_cvt_pk_bf16_f32 v37, v33, v33
    v_cvt_pk_bf16_f32 v38, v34, v34
    v_cvt_pk_bf16_f32 v39, v35, v35
    v_add_f32 v62, v32, v33
    v_add_f32 v63, v34, v35
    v_add_f32 v62, v62, v63
    s_nop 1
    v_add_f32_dpp v62, v62, v62 row_ror:8 row_mask:0xf bank_mask:0xf
    s_nop 1
    v_add_f32_dpp v62, v62, v62 row_ror:4 row_mask:0xf bank_mask:0xf
    s_nop 1
    v_add_f32_dpp v62, v62, v62 row_ror:2 row_mask:0xf bank_mask:0xf
    s_nop 1
    v_add_f32_dpp v62, v62, v62 row_ror:1 row_mask:0xf bank_mask:0xf
    v_mov_b32 v63, v62
    s_nop 1
    v_permlane16_swap_b32 v62, v63
    v_add_f32 v62, v62, v63
    v_mov_b32 v63, v62
    s_nop 1
    v_permlane32_swap_b32 v62, v63
    v_add_f32 v62, v62, v63
    ds_write_b32 v9, v62 offset:64
    v_bfe_u32 v9, v0, 4, 1
    v_and_b32 v63, 7, v0
    v_lshl_add_u32 v9, v9, 3, v63
    v_lshlrev_b32 v9, 4, v9
    v_lshrrev_b32 v63, 5, v0
    v_lshl_add_u32 v9, v63, 2, v9
    s_mul_i32 s53, s3, 768
    s_add_u32 s53, s53, 49152
    v_add_u32 v9, s53, v9
    ds_bpermute_b32 v60, v4, v38 offset:64
    s_waitcnt lgkmcnt(0)
    v_and_b32 v52, v60, v5
    v_and_b32 v53, v60, v6
    v_and_b32 v54, v60, v7
    v_and_b32 v55, v60, v8
    ds_bpermute_b32 v61, v4, v38 offset:96
    ds_read_b128 v[32:35], v3 offset:0
    v_mfma_f32_16x16x32_bf16 v[40:43], v[236:239], v[52:55], 0
    v_mfma_f32_16x16x32_bf16 v[44:47], v[240:243], v[52:55], 0
    v_mfma_f32_16x16x32_bf16 v[48:51], v[244:247], v[52:55], 0
    s_add_u32 s71, s52, 36864
    buffer_load_dwordx4 a[36:39], v2, s[8:11], s71 offen offset:0 sc1 nt
    s_waitcnt lgkmcnt(0)
    v_and_b32 v56, v61, v5
    v_and_b32 v57, v61, v6
    v_and_b32 v58, v61, v7
    v_and_b32 v59, v61, v8
    ds_bpermute_b32 v60, v4, v38 offset:128
    ds_read_b128 v[12:15], v3 offset:1024
    ds_read_b128 v[16:19], v3 offset:2048
    ds_read_b128 v[20:23], v3 offset:3072
    v_mfma_f32_16x16x32_bf16 v[40:43], v[248:251], v[56:59], v[40:43]
    v_mfma_f32_16x16x32_bf16 v[44:47], v[252:255], v[56:59], v[44:47]
    v_mfma_f32_16x16x32_bf16 v[48:51], v[32:35], v[56:59], v[48:51]
    buffer_load_dwordx4 a[40:43], v2, s[8:11], s71 offen offset:128 sc1 nt
    s_waitcnt lgkmcnt(0)
    v_and_b32 v52, v60, v5
    v_and_b32 v53, v60, v6
    v_and_b32 v54, v60, v7
    v_and_b32 v55, v60, v8
    ds_bpermute_b32 v61, v4, v38 offset:160
    ds_read_b128 v[24:27], v3 offset:4096
    ds_read_b128 v[28:31], v3 offset:5120
    ds_read_b128 v[32:35], v3 offset:6144
    v_mfma_f32_16x16x32_bf16 v[40:43], v[12:15], v[52:55], v[40:43]
    v_mfma_f32_16x16x32_bf16 v[44:47], v[16:19], v[52:55], v[44:47]
    v_mfma_f32_16x16x32_bf16 v[48:51], v[20:23], v[52:55], v[48:51]
    buffer_load_dwordx4 a[44:47], v2, s[8:11], s71 offen offset:256 sc1 nt
    s_waitcnt lgkmcnt(0)
    v_and_b32 v56, v61, v5
    v_and_b32 v57, v61, v6
    v_and_b32 v58, v61, v7
    v_and_b32 v59, v61, v8
    ds_bpermute_b32 v60, v4, v38 offset:192
    ds_read_b128 v[12:15], v3 offset:7168
    ds_read_b128 v[16:19], v3 offset:8192
    ds_read_b128 v[20:23], v3 offset:9216
    v_mfma_f32_16x16x32_bf16 v[40:43], v[24:27], v[56:59], v[40:43]
    v_mfma_f32_16x16x32_bf16 v[44:47], v[28:31], v[56:59], v[44:47]
    v_mfma_f32_16x16x32_bf16 v[48:51], v[32:35], v[56:59], v[48:51]
    s_add_u32 s71, s52, 18432
    buffer_load_dwordx4 a[48:51], v2, s[8:11], s71 offen offset:0 sc1 nt
    s_waitcnt lgkmcnt(0)
    v_and_b32 v52, v60, v5
    v_and_b32 v53, v60, v6
    v_and_b32 v54, v60, v7
    v_and_b32 v55, v60, v8
    ds_bpermute_b32 v61, v4, v38 offset:224
    ds_read_b128 v[24:27], v3 offset:10240
    ds_read_b128 v[28:31], v3 offset:11264
    ds_read_b128 v[32:35], v3 offset:12288
    v_mfma_f32_16x16x32_bf16 v[40:43], v[12:15], v[52:55], v[40:43]
    v_mfma_f32_16x16x32_bf16 v[44:47], v[16:19], v[52:55], v[44:47]
    v_mfma_f32_16x16x32_bf16 v[48:51], v[20:23], v[52:55], v[48:51]
    buffer_load_dwordx4 a[52:55], v2, s[8:11], s71 offen offset:128 sc1 nt
    s_waitcnt lgkmcnt(0)
    v_and_b32 v56, v61, v5
    v_and_b32 v57, v61, v6
    v_and_b32 v58, v61, v7
    v_and_b32 v59, v61, v8
    ds_bpermute_b32 v60, v4, v39 offset:0
    ds_read_b128 v[12:15], v3 offset:13312
    ds_read_b128 v[16:19], v3 offset:14336
    ds_read_b128 v[20:23], v3 offset:15360
    v_mfma_f32_16x16x32_bf16 v[40:43], v[24:27], v[56:59], v[40:43]
    v_mfma_f32_16x16x32_bf16 v[44:47], v[28:31], v[56:59], v[44:47]
    v_mfma_f32_16x16x32_bf16 v[48:51], v[32:35], v[56:59], v[48:51]
    buffer_load_dwordx4 a[56:59], v2, s[8:11], s71 offen offset:256 sc1 nt
    s_waitcnt lgkmcnt(0)
    v_and_b32 v52, v60, v5
    v_and_b32 v53, v60, v6
    v_and_b32 v54, v60, v7
    v_and_b32 v55, v60, v8
    ds_bpermute_b32 v61, v4, v39 offset:32
    ds_read_b128 v[24:27], v3 offset:16384
    ds_read_b128 v[28:31], v3 offset:17408
    ds_read_b128 v[32:35], v3 offset:18432
    v_mfma_f32_16x16x32_bf16 v[40:43], v[12:15], v[52:55], v[40:43]
    v_mfma_f32_16x16x32_bf16 v[44:47], v[16:19], v[52:55], v[44:47]
    v_mfma_f32_16x16x32_bf16 v[48:51], v[20:23], v[52:55], v[48:51]
    s_add_u32 s71, s52, 39936
    buffer_load_dwordx4 a[60:63], v2, s[8:11], s71 offen offset:0 sc1 nt
    s_waitcnt lgkmcnt(0)
    v_and_b32 v56, v61, v5
    v_and_b32 v57, v61, v6
    v_and_b32 v58, v61, v7
    v_and_b32 v59, v61, v8
    ds_bpermute_b32 v60, v4, v39 offset:64
    ds_read_b128 v[12:15], v3 offset:19456
    ds_read_b128 v[16:19], v3 offset:20480
    ds_read_b128 v[20:23], v3 offset:21504
    v_mfma_f32_16x16x32_bf16 v[40:43], v[24:27], v[56:59], v[40:43]
    v_mfma_f32_16x16x32_bf16 v[44:47], v[28:31], v[56:59], v[44:47]
    v_mfma_f32_16x16x32_bf16 v[48:51], v[32:35], v[56:59], v[48:51]
    buffer_load_dwordx4 a[64:67], v2, s[8:11], s71 offen offset:128 sc1 nt
    s_waitcnt lgkmcnt(0)
    v_and_b32 v52, v60, v5
    v_and_b32 v53, v60, v6
    v_and_b32 v54, v60, v7
    v_and_b32 v55, v60, v8
    ds_bpermute_b32 v61, v4, v39 offset:96
    ds_read_b128 v[24:27], v3 offset:22528
    ds_read_b128 v[28:31], v3 offset:23552
    ds_read_b128 v[32:35], v3 offset:24576
    v_mfma_f32_16x16x32_bf16 v[40:43], v[12:15], v[52:55], v[40:43]
    v_mfma_f32_16x16x32_bf16 v[44:47], v[16:19], v[52:55], v[44:47]
    v_mfma_f32_16x16x32_bf16 v[48:51], v[20:23], v[52:55], v[48:51]
    buffer_load_dwordx4 a[68:71], v2, s[8:11], s71 offen offset:256 sc1 nt
    s_waitcnt lgkmcnt(0)
    v_and_b32 v56, v61, v5
    v_and_b32 v57, v61, v6
    v_and_b32 v58, v61, v7
    v_and_b32 v59, v61, v8
    ds_bpermute_b32 v60, v4, v39 offset:128
    ds_read_b128 v[12:15], v3 offset:25600
    ds_read_b128 v[16:19], v3 offset:26624
    v_mfma_f32_16x16x32_bf16 v[40:43], v[24:27], v[56:59], v[40:43]
    v_mfma_f32_16x16x32_bf16 v[44:47], v[28:31], v[56:59], v[44:47]
    v_mfma_f32_16x16x32_bf16 v[48:51], v[32:35], v[56:59], v[48:51]
    s_add_u32 s71, s52, 21504
    buffer_load_dwordx4 a[72:75], v2, s[8:11], s71 offen offset:0 sc1 nt
    s_waitcnt lgkmcnt(0)
    v_and_b32 v52, v60, v5
    v_and_b32 v53, v60, v6
    v_and_b32 v54, v60, v7
    v_and_b32 v55, v60, v8
    ds_bpermute_b32 v61, v4, v39 offset:160
    s_nop 0
    v_mfma_f32_16x16x32_bf16 v[40:43], v[12:15], v[52:55], v[40:43]
    v_mfma_f32_16x16x32_bf16 v[44:47], v[16:19], v[52:55], v[44:47]
    v_mfma_f32_16x16x32_bf16 v[48:51], v[192:195], v[52:55], v[48:51]
    buffer_load_dwordx4 a[76:79], v2, s[8:11], s71 offen offset:128 sc1 nt
    s_waitcnt lgkmcnt(0)
    v_and_b32 v56, v61, v5
    v_and_b32 v57, v61, v6
    v_and_b32 v58, v61, v7
    v_and_b32 v59, v61, v8
    ds_bpermute_b32 v60, v4, v39 offset:192
    s_nop 0
    v_mfma_f32_16x16x32_bf16 v[40:43], v[196:199], v[56:59], v[40:43]
    v_mfma_f32_16x16x32_bf16 v[44:47], v[200:203], v[56:59], v[44:47]
    v_mfma_f32_16x16x32_bf16 v[48:51], v[204:207], v[56:59], v[48:51]
    buffer_load_dwordx4 a[80:83], v2, s[8:11], s71 offen offset:256 sc1 nt
    s_waitcnt lgkmcnt(0)
    v_and_b32 v52, v60, v5
    v_and_b32 v53, v60, v6
    v_and_b32 v54, v60, v7
    v_and_b32 v55, v60, v8
    ds_bpermute_b32 v61, v4, v39 offset:224
    s_nop 0
    v_mfma_f32_16x16x32_bf16 v[40:43], v[208:211], v[52:55], v[40:43]
    v_mfma_f32_16x16x32_bf16 v[44:47], v[212:215], v[52:55], v[44:47]
    v_mfma_f32_16x16x32_bf16 v[48:51], v[216:219], v[52:55], v[48:51]
    s_add_u32 s71, s52, 43008
    buffer_load_dwordx4 a[84:87], v2, s[8:11], s71 offen offset:0 sc1 nt
    s_waitcnt lgkmcnt(0)
    v_and_b32 v56, v61, v5
    v_and_b32 v57, v61, v6
    v_and_b32 v58, v61, v7
    v_and_b32 v59, v61, v8
    ds_bpermute_b32 v60, v4, v36 offset:0
    s_waitcnt vmcnt(33)
    ds_read_b128 v[12:15], v10 offset:10240
    s_waitcnt vmcnt(32)
    ds_read_b128 v[16:19], v10 offset:11264
    s_waitcnt vmcnt(31)
    ds_read_b128 v[20:23], v10 offset:0
    v_mfma_f32_16x16x32_bf16 v[40:43], v[220:223], v[56:59], v[40:43]
    v_mfma_f32_16x16x32_bf16 v[44:47], v[224:227], v[56:59], v[44:47]
    v_mfma_f32_16x16x32_bf16 v[48:51], v[228:231], v[56:59], v[48:51]
    buffer_load_dwordx4 a[88:91], v2, s[8:11], s71 offen offset:128 sc1 nt
    s_waitcnt lgkmcnt(0)
    v_and_b32 v52, v60, v5
    v_and_b32 v53, v60, v6
    v_and_b32 v54, v60, v7
    v_and_b32 v55, v60, v8
    ds_bpermute_b32 v61, v4, v36 offset:32
    s_waitcnt vmcnt(31)
    ds_read_b128 v[24:27], v10 offset:1024
    s_waitcnt vmcnt(30)
    ds_read_b128 v[28:31], v10 offset:2048
    s_waitcnt vmcnt(29)
    ds_read_b128 v[32:35], v10 offset:3072
    v_mfma_f32_16x16x32_bf16 v[40:43], v[12:15], v[52:55], v[40:43]
    v_mfma_f32_16x16x32_bf16 v[44:47], v[16:19], v[52:55], v[44:47]
    v_mfma_f32_16x16x32_bf16 v[48:51], v[20:23], v[52:55], v[48:51]
    buffer_load_dwordx4 a[92:95], v2, s[8:11], s71 offen offset:256 sc1 nt
    s_add_u32 s71, s52, 24576
    buffer_load_dwordx4 a[96:99], v2, s[8:11], s71 offen offset:0 sc1 nt
    buffer_load_dwordx4 a[100:103], v2, s[8:11], s71 offen offset:128 sc1 nt
    s_waitcnt lgkmcnt(0)
    v_and_b32 v56, v61, v5
    v_and_b32 v57, v61, v6
    v_and_b32 v58, v61, v7
    v_and_b32 v59, v61, v8
    ds_bpermute_b32 v60, v4, v36 offset:64
    s_waitcnt vmcnt(31)
    ds_read_b128 v[12:15], v10 offset:4096
    s_waitcnt vmcnt(30)
    ds_read_b128 v[16:19], v10 offset:5120
    s_waitcnt vmcnt(29)
    ds_read_b128 v[20:23], v10 offset:6144
    v_mfma_f32_16x16x32_bf16 v[40:43], v[24:27], v[56:59], v[40:43]
    v_mfma_f32_16x16x32_bf16 v[44:47], v[28:31], v[56:59], v[44:47]
    v_mfma_f32_16x16x32_bf16 v[48:51], v[32:35], v[56:59], v[48:51]
    buffer_load_dwordx4 a[104:107], v2, s[8:11], s71 offen offset:256 sc1 nt
    s_add_u32 s71, s52, 46080
    buffer_load_dwordx4 a[108:111], v2, s[8:11], s71 offen offset:0 sc1 nt
    buffer_load_dwordx4 a[112:115], v2, s[8:11], s71 offen offset:128 sc1 nt
    s_waitcnt lgkmcnt(0)
    v_and_b32 v52, v60, v5
    v_and_b32 v53, v60, v6
    v_and_b32 v54, v60, v7
    v_and_b32 v55, v60, v8
    ds_bpermute_b32 v61, v4, v36 offset:96
    s_waitcnt vmcnt(31)
    ds_read_b128 v[24:27], v10 offset:7168
    s_waitcnt vmcnt(30)
    ds_read_b128 v[28:31], v10 offset:8192
    s_waitcnt vmcnt(29)
    ds_read_b128 v[32:35], v10 offset:9216
    v_mfma_f32_16x16x32_bf16 v[40:43], v[12:15], v[52:55], v[40:43]
    v_mfma_f32_16x16x32_bf16 v[44:47], v[16:19], v[52:55], v[44:47]
    v_mfma_f32_16x16x32_bf16 v[48:51], v[20:23], v[52:55], v[48:51]
    buffer_load_dwordx4 a[116:119], v2, s[8:11], s71 offen offset:256 sc1 nt
    s_add_u32 s71, s52, 27648
    buffer_load_dwordx4 a[120:123], v2, s[8:11], s71 offen offset:0 sc1 nt
    buffer_load_dwordx4 a[124:127], v2, s[8:11], s71 offen offset:128 sc1 nt
    s_waitcnt lgkmcnt(0)
    v_and_b32 v56, v61, v5
    v_and_b32 v57, v61, v6
    v_and_b32 v58, v61, v7
    v_and_b32 v59, v61, v8
    ds_bpermute_b32 v60, v4, v36 offset:128
    s_nop 0
    v_mfma_f32_16x16x32_bf16 v[40:43], v[24:27], v[56:59], v[40:43]
    v_mfma_f32_16x16x32_bf16 v[44:47], v[28:31], v[56:59], v[44:47]
    v_mfma_f32_16x16x32_bf16 v[48:51], v[32:35], v[56:59], v[48:51]
    buffer_load_dwordx4 a[128:131], v2, s[8:11], s71 offen offset:256 sc1 nt
    s_add_u32 s71, s52, 49152
    buffer_load_dwordx4 a[132:135], v2, s[8:11], s71 offen offset:0 sc1 nt
    buffer_load_dwordx4 a[136:139], v2, s[8:11], s71 offen offset:128 sc1 nt
    v_bfe_u32 v62, v0, 2, 2
    v_lshlrev_b32 v62, 3, v62
    v_lshrrev_b32 v63, 5, v0
    v_lshl_add_u32 v62, v63, 1, v62
    v_bfe_u32 v63, v0, 4, 1
    v_add_u32 v62, v62, v63
    v_mul_u32_u24 v62, 1280, v62
    v_and_b32 v63, 3, v0
    v_lshl_add_u32 v62, v63, 4, v62
    s_mul_i32 s53, s54, 983040
    s_mul_i32 s69, s3, 245760
    s_add_u32 s53, s53, s69
    s_lshl_b32 s69, s63, 6
    s_add_u32 s53, s53, s69
    s_lshl_b32 s70, s74, 10
    s_cmp_eq_u32 s74, 1
    s_cselect_b32 s69, 0, 11264
    s_add_u32 m0, s66, s69
    s_add_u32 s69, s53, 0
    buffer_load_dwordx4 v62, s[20:23], s69 offen lds
    s_add_u32 m0, m0, s70
    s_add_u32 s69, s53, 5120
    buffer_load_dwordx4 v62, s[20:23], s69 offen lds
    s_add_u32 m0, m0, s70
    s_add_u32 s69, s53, 40960
    buffer_load_dwordx4 v62, s[20:23], s69 offen lds
    s_add_u32 m0, m0, s70
    s_add_u32 s69, s53, 46080
    buffer_load_dwordx4 v62, s[20:23], s69 offen lds
    s_add_u32 m0, m0, s70
    s_add_u32 s69, s53, 81920
    buffer_load_dwordx4 v62, s[20:23], s69 offen lds
    s_add_u32 m0, m0, s70
    s_add_u32 s69, s53, 87040
    buffer_load_dwordx4 v62, s[20:23], s69 offen lds
    s_add_u32 m0, m0, s70
    s_add_u32 s69, s53, 122880
    buffer_load_dwordx4 v62, s[20:23], s69 offen lds
    s_add_u32 m0, m0, s70
    s_add_u32 s69, s53, 128000
    buffer_load_dwordx4 v62, s[20:23], s69 offen lds
    s_add_u32 m0, m0, s70
    s_add_u32 s69, s53, 163840
    buffer_load_dwordx4 v62, s[20:23], s69 offen lds
    s_add_u32 m0, m0, s70
    s_add_u32 s69, s53, 168960
    buffer_load_dwordx4 v62, s[20:23], s69 offen lds
    s_add_u32 m0, m0, s70
    s_add_u32 s69, s53, 204800
    buffer_load_dwordx4 v62, s[20:23], s69 offen lds
    s_add_u32 m0, m0, s70
    s_add_u32 s69, s53, 209920
    buffer_load_dwordx4 v62, s[20:23], s69 offen lds
    s_waitcnt lgkmcnt(0)
    v_and_b32 v52, v60, v5
    v_and_b32 v53, v60, v6
    v_and_b32 v54, v60, v7
    v_and_b32 v55, v60, v8
    ds_bpermute_b32 v61, v4, v37 offset:96
    s_waitcnt vmcnt(46)
    v_mfma_f32_16x16x32_bf16 v[40:43], a[0:3], v[52:55], v[40:43]
    s_waitcnt vmcnt(45)
    v_mfma_f32_16x16x32_bf16 v[44:47], a[4:7], v[52:55], v[44:47]
    s_waitcnt vmcnt(44)
    v_mfma_f32_16x16x32_bf16 v[48:51], a[8:11], v[52:55], v[48:51]
    buffer_load_dwordx4 a[140:143], v2, s[8:11], s71 offen offset:256 sc1 nt
    s_add_u32 s71, s52, 30720
    buffer_load_dwordx4 a[144:147], v2, s[8:11], s71 offen offset:0 sc1 nt
    buffer_load_dwordx4 a[148:151], v2, s[8:11], s71 offen offset:128 sc1 nt
    s_waitcnt lgkmcnt(0)
    v_and_b32 v56, v61, v5
    v_and_b32 v57, v61, v6
    v_and_b32 v58, v61, v7
    v_and_b32 v59, v61, v8
    ds_bpermute_b32 v60, v4, v36 offset:160
    s_waitcnt vmcnt(46)
    v_mfma_f32_16x16x32_bf16 v[40:43], a[12:15], v[56:59], v[40:43]
    s_waitcnt vmcnt(45)
    v_mfma_f32_16x16x32_bf16 v[44:47], a[16:19], v[56:59], v[44:47]
    s_waitcnt vmcnt(44)
    v_mfma_f32_16x16x32_bf16 v[48:51], a[20:23], v[56:59], v[48:51]
    buffer_load_dwordx4 a[152:155], v2, s[8:11], s71 offen offset:256 sc1 nt
    s_add_u32 s71, s52, 52224
    buffer_load_dwordx4 a[156:159], v2, s[8:11], s71 offen offset:0 sc1 nt
    buffer_load_dwordx4 a[160:163], v2, s[8:11], s71 offen offset:128 sc1 nt
    s_waitcnt lgkmcnt(0)
    v_and_b32 v52, v60, v5
    v_and_b32 v53, v60, v6
    v_and_b32 v54, v60, v7
    v_and_b32 v55, v60, v8
    ds_bpermute_b32 v61, v4, v37 offset:128
    s_waitcnt vmcnt(46)
    v_mfma_f32_16x16x32_bf16 v[40:43], a[24:27], v[52:55], v[40:43]
    s_waitcnt vmcnt(45)
    v_mfma_f32_16x16x32_bf16 v[44:47], a[28:31], v[52:55], v[44:47]
    s_waitcnt vmcnt(44)
    v_mfma_f32_16x16x32_bf16 v[48:51], a[32:35], v[52:55], v[48:51]
    s_waitcnt lgkmcnt(0)
    v_and_b32 v56, v61, v5
    v_and_b32 v57, v61, v6
    v_and_b32 v58, v61, v7
    v_and_b32 v59, v61, v8
    ds_bpermute_b32 v60, v4, v36 offset:192
    s_waitcnt vmcnt(43)
    v_mfma_f32_16x16x32_bf16 v[40:43], a[36:39], v[56:59], v[40:43]
    s_waitcnt vmcnt(42)
    v_mfma_f32_16x16x32_bf16 v[44:47], a[40:43], v[56:59], v[44:47]
    s_waitcnt vmcnt(41)
    v_mfma_f32_16x16x32_bf16 v[48:51], a[44:47], v[56:59], v[48:51]
    s_waitcnt lgkmcnt(0)
    v_and_b32 v52, v60, v5
    v_and_b32 v53, v60, v6
    v_and_b32 v54, v60, v7
    v_and_b32 v55, v60, v8
    ds_bpermute_b32 v61, v4, v37 offset:160
    s_waitcnt vmcnt(40)
    v_mfma_f32_16x16x32_bf16 v[40:43], a[48:51], v[52:55], v[40:43]
    s_waitcnt vmcnt(39)
    v_mfma_f32_16x16x32_bf16 v[44:47], a[52:55], v[52:55], v[44:47]
    s_waitcnt vmcnt(38)
    v_mfma_f32_16x16x32_bf16 v[48:51], a[56:59], v[52:55], v[48:51]
    s_waitcnt lgkmcnt(0)
    v_and_b32 v56, v61, v5
    v_and_b32 v57, v61, v6
    v_and_b32 v58, v61, v7
    v_and_b32 v59, v61, v8
    ds_bpermute_b32 v60, v4, v36 offset:224
    s_waitcnt vmcnt(37)
    v_mfma_f32_16x16x32_bf16 v[40:43], a[60:63], v[56:59], v[40:43]
    s_waitcnt vmcnt(36)
    v_mfma_f32_16x16x32_bf16 v[44:47], a[64:67], v[56:59], v[44:47]
    s_waitcnt vmcnt(35)
    v_mfma_f32_16x16x32_bf16 v[48:51], a[68:71], v[56:59], v[48:51]
    s_waitcnt lgkmcnt(0)
    v_and_b32 v52, v60, v5
    v_and_b32 v53, v60, v6
    v_and_b32 v54, v60, v7
    v_and_b32 v55, v60, v8
    ds_bpermute_b32 v61, v4, v37 offset:192
    s_waitcnt vmcnt(34)
    v_mfma_f32_16x16x32_bf16 v[40:43], a[72:75], v[52:55], v[40:43]
    s_waitcnt vmcnt(33)
    v_mfma_f32_16x16x32_bf16 v[44:47], a[76:79], v[52:55], v[44:47]
    s_waitcnt vmcnt(32)
    v_mfma_f32_16x16x32_bf16 v[48:51], a[80:83], v[52:55], v[48:51]
    s_waitcnt lgkmcnt(0)
    v_and_b32 v56, v61, v5
    v_and_b32 v57, v61, v6
    v_and_b32 v58, v61, v7
    v_and_b32 v59, v61, v8
    ds_bpermute_b32 v60, v4, v37 offset:0
    s_waitcnt vmcnt(31)
    v_mfma_f32_16x16x32_bf16 v[40:43], a[84:87], v[56:59], v[40:43]
    s_waitcnt vmcnt(30)
    v_mfma_f32_16x16x32_bf16 v[44:47], a[88:91], v[56:59], v[44:47]
    s_waitcnt vmcnt(29)
    v_mfma_f32_16x16x32_bf16 v[48:51], a[92:95], v[56:59], v[48:51]
    s_waitcnt lgkmcnt(0)
    v_and_b32 v52, v60, v5
    v_and_b32 v53, v60, v6
    v_and_b32 v54, v60, v7
    v_and_b32 v55, v60, v8
    ds_bpermute_b32 v61, v4, v37 offset:224
    s_waitcnt vmcnt(28)
    v_mfma_f32_16x16x32_bf16 v[40:43], a[96:99], v[52:55], v[40:43]
    s_waitcnt vmcnt(27)
    v_mfma_f32_16x16x32_bf16 v[44:47], a[100:103], v[52:55], v[44:47]
    s_waitcnt vmcnt(26)
    v_mfma_f32_16x16x32_bf16 v[48:51], a[104:107], v[52:55], v[48:51]
    s_waitcnt lgkmcnt(0)
    v_and_b32 v56, v61, v5
    v_and_b32 v57, v61, v6
    v_and_b32 v58, v61, v7
    v_and_b32 v59, v61, v8
    ds_bpermute_b32 v60, v4, v37 offset:32
    s_waitcnt vmcnt(25)
    v_mfma_f32_16x16x32_bf16 v[40:43], a[108:111], v[56:59], v[40:43]
    s_waitcnt vmcnt(24)
    v_mfma_f32_16x16x32_bf16 v[44:47], a[112:115], v[56:59], v[44:47]
    s_waitcnt vmcnt(23)
    v_mfma_f32_16x16x32_bf16 v[48:51], a[116:119], v[56:59], v[48:51]
    s_waitcnt lgkmcnt(0)
    v_and_b32 v52, v60, v5
    v_and_b32 v53, v60, v6
    v_and_b32 v54, v60, v7
    v_and_b32 v55, v60, v8
    ds_bpermute_b32 v61, v4, v38 offset:0
    s_waitcnt vmcnt(22)
    v_mfma_f32_16x16x32_bf16 v[40:43], a[120:123], v[52:55], v[40:43]
    s_waitcnt vmcnt(21)
    v_mfma_f32_16x16x32_bf16 v[44:47], a[124:127], v[52:55], v[44:47]
    s_waitcnt vmcnt(20)
    v_mfma_f32_16x16x32_bf16 v[48:51], a[128:131], v[52:55], v[48:51]
    s_waitcnt lgkmcnt(0)
    v_and_b32 v56, v61, v5
    v_and_b32 v57, v61, v6
    v_and_b32 v58, v61, v7
    v_and_b32 v59, v61, v8
    ds_bpermute_b32 v60, v4, v37 offset:64
    s_waitcnt vmcnt(19)
    v_mfma_f32_16x16x32_bf16 v[40:43], a[132:135], v[56:59], v[40:43]
    s_waitcnt vmcnt(18)
    v_mfma_f32_16x16x32_bf16 v[44:47], a[136:139], v[56:59], v[44:47]
    s_waitcnt vmcnt(5)
    v_mfma_f32_16x16x32_bf16 v[48:51], a[140:143], v[56:59], v[48:51]
    s_waitcnt lgkmcnt(0)
    v_and_b32 v52, v60, v5
    v_and_b32 v53, v60, v6
    v_and_b32 v54, v60, v7
    v_and_b32 v55, v60, v8
    ds_bpermute_b32 v61, v4, v38 offset:32
    s_waitcnt vmcnt(4)
    v_mfma_f32_16x16x32_bf16 v[40:43], a[144:147], v[52:55], v[40:43]
    s_waitcnt vmcnt(3)
    v_mfma_f32_16x16x32_bf16 v[44:47], a[148:151], v[52:55], v[44:47]
    s_waitcnt vmcnt(2)
    v_mfma_f32_16x16x32_bf16 v[48:51], a[152:155], v[52:55], v[48:51]
    s_waitcnt lgkmcnt(0)
    v_and_b32 v56, v61, v5
    v_and_b32 v57, v61, v6
    v_and_b32 v58, v61, v7
    v_and_b32 v59, v61, v8
    s_waitcnt vmcnt(1)
    s_nop 0
    v_mfma_f32_16x16x32_bf16 v[40:43], a[156:159], v[56:59], v[40:43]
    s_waitcnt vmcnt(0)
    v_mfma_f32_16x16x32_bf16 v[44:47], a[160:163], v[56:59], v[44:47]
    v_mfma_f32_16x16x32_bf16 v[48:51], v[232:235], v[56:59], v[48:51]
    s_nop 4
    v_permlane32_swap_b32 v40, v41
    v_permlane32_swap_b32 v42, v43
    v_permlane32_swap_b32 v44, v45
    v_permlane32_swap_b32 v46, v47
    v_permlane32_swap_b32 v48, v49
    v_permlane32_swap_b32 v50, v51
    v_add_f32_dpp v40, v41, v40 row_ror:8 row_mask:0xf bank_mask:0xf
    v_add_f32_dpp v42, v43, v42 row_ror:8 row_mask:0xf bank_mask:0xf
    v_add_f32_dpp v44, v45, v44 row_ror:8 row_mask:0xf bank_mask:0xf
    v_add_f32_dpp v46, v47, v46 row_ror:8 row_mask:0xf bank_mask:0xf
    v_add_f32_dpp v48, v49, v48 row_ror:8 row_mask:0xf bank_mask:0xf
    v_add_f32_dpp v50, v51, v50 row_ror:8 row_mask:0xf bank_mask:0xf
    s_mov_b32 exec_lo, 0x00ff00ff
    s_mov_b32 exec_hi, 0x00ff00ff
    ds_write2_b32 v9, v40, v42 offset0:0 offset1:2
    ds_write2_b32 v9, v44, v46 offset0:64 offset1:66
    ds_write2_b32 v9, v48, v50 offset0:128 offset1:130
    s_mov_b64 exec, -1
    v_min_u32 v62, 47, v0
    v_lshlrev_b32 v62, 4, v62
    v_add_u32 v62, 49152, v62
    v_mov_b32 v63, 52288
    v_lshlrev_b32 v10, 3, v0
    s_add_u32 s53, s76, s61
    v_cmp_eq_u32 vcc, 48, v0
    s_waitcnt lgkmcnt(0)
    s_barrier
    s_cmp_eq_u32 s3, 3
    s_nop 1
    s_cbranch_scc1 L_afin_59
    s_barrier
    s_branch L_ajoin_60
L_afin_59:
    ds_read_b128 v[12:15], v62 offset:0
    ds_read_b128 v[16:19], v62 offset:768
    ds_read_b128 v[20:23], v62 offset:1536
    ds_read_b128 v[24:27], v62 offset:2304
    ds_read_b128 v[28:31], v63
    s_waitcnt lgkmcnt(0)
    v_pk_add_f32 v[12:13], v[12:13], v[16:17]
    v_pk_add_f32 v[14:15], v[14:15], v[18:19]
    v_pk_add_f32 v[20:21], v[20:21], v[24:25]
    v_pk_add_f32 v[22:23], v[22:23], v[26:27]
    v_pk_add_f32 v[28:29], v[28:29], v[30:31]
    v_pk_add_f32 v[12:13], v[12:13], v[20:21]
    v_pk_add_f32 v[14:15], v[14:15], v[22:23]
    v_add_f32 v28, v28, v29
    v_cvt_pk_bf16_f32 v12, v12, v13
    v_cvt_pk_bf16_f32 v13, v14, v15
    v_cndmask_b32 v12, v12, v11, vcc
    v_cndmask_b32 v13, v13, v28, vcc
    v_min_u32 v12, -2, v12
    v_min_u32 v13, -2, v13
    s_mov_b32 exec_lo, -1
    s_mov_b32 exec_hi, 0x1ffff
    s_cmp_eq_u32 s87, 1
    s_cbranch_scc1 L_pfast_61
    buffer_store_dwordx2 v[12:13], v10, s[12:15], s53 offen sc1
    s_branch L_pjoin_62
L_pfast_61:
    buffer_store_dwordx2 v[12:13], v10, s[12:15], s53 offen
L_pjoin_62:
    s_mov_b64 exec, -1
    s_barrier
L_ajoin_60:
    s_branch L_chain
L_fin:
L_end:
    s_endpgm

.section .rodata,"a"
.p2align 6
.amdhsa_kernel interleave_layers__mha_block_cached__glu_gated_reglu__decode_kernel
  .amdhsa_next_free_vgpr 512
  .amdhsa_next_free_sgpr 102
  .amdhsa_accum_offset 256
  .amdhsa_group_segment_fixed_size 0
  .amdhsa_kernarg_size 96
  .amdhsa_user_sgpr_count 2
  .amdhsa_user_sgpr_kernarg_segment_ptr 1
  .amdhsa_system_sgpr_workgroup_id_x 1
.end_amdhsa_kernel
```
